```python
import torch

def _softmax(x, axis=-1):
    return torch.softmax(x, dim=axis)
def _gelu(x):
    return torch.nn.functional.gelu(x, approximate="tanh")
def _silu(x):
    return torch.nn.functional.silu(x)
def _sigmoid(x):
    return torch.sigmoid(x)
def _layernorm(x, axis=-1, eps=1e-5):
    m = x.mean(dim=axis, keepdim=True)
    v = x.var(dim=axis, keepdim=True, unbiased=False)
    return (x - m) / torch.sqrt(v + eps)
def _scatter_add(tgt, idx, src, axis=0):
    return tgt.clone().index_add_(axis, idx, src)
def _segment_sum(src, seg, n):
    out = torch.zeros((n,) + src.shape[1:], dtype=src.dtype)
    return out.index_add_(0, seg, src)
def _pad(x, pw):
    flat = tuple(v for pair in reversed(pw) for v in pair)
    return torch.nn.functional.pad(x, flat)

kernel_name = 'concat_heads__sliding_block_cached__compressed_kv_cla__decode'

def setup_inputs():

    _w = (lambda a: (lambda t: t.to(torch.bfloat16) if t.is_floating_point() else t)(torch.as_tensor(a)))
    def _A_setup():
        B, Sq, D = 2, 1, 512
        Hq, Hkv, Sk, Dh = 32, 8, 8192, 128
        assert Hq % Hkv == 0, (Hq, Hkv)
        return {
            "x": _w((lambda *s: torch.randn(*s, dtype=torch.bfloat16) * 1.6)(B, Sq, D)),
            "k_cache": _w((lambda *s: torch.randn(*s, dtype=torch.bfloat16) * 1.6)(B, Hkv, Sk, Dh)),
            "v_cache": _w((lambda *s: torch.randn(*s, dtype=torch.bfloat16) * 0.05)(B, Hkv, Sk, Dh)),
            "wq": _w((lambda *s: torch.randn(*s, dtype=torch.bfloat16) * 1.6)(D, Hq * Dh) * (D ** -0.5)),
            "wo": _w((lambda *s: torch.randn(*s, dtype=torch.bfloat16) * 0.05)(Hq * Dh, D) * ((Hq * Dh) ** -0.5)),
        }
    _A_in = _A_setup()

    def _B_setup():
        B, H, Sq, Sk, D, M = 2, 32, 1, 8192, 128, 512
        Dc = 4 * D
        return {
            "x": _w((lambda *s: torch.randn(*s, dtype=torch.bfloat16) * 3.2)(B, Sq, M)),
            "c_kv": _w((lambda *s: torch.randn(*s, dtype=torch.bfloat16) * 0.1)(B, Sk, Dc)),
            "w_q": _w((lambda *s: torch.randn(*s, dtype=torch.bfloat16) * 6.4)(M, H, D) * (M ** -0.5)),
            "w_uk": _w((lambda *s: torch.randn(*s, dtype=torch.bfloat16) * 6.4)(Dc, H, D) * (Dc ** -0.5)),
            "w_uv": _w((lambda *s: torch.randn(*s, dtype=torch.bfloat16) * 0.1)(Dc, H, D) * (Dc ** -0.5)),
            "w_o": _w((lambda *s: torch.randn(*s, dtype=torch.bfloat16) * 0.1)(H, D, M) * ((H * D) ** -0.5)),
        }
    _B_in = _B_setup()

    return {
        "A_x": _A_in["x"],
        "A_k_cache": _A_in["k_cache"],
        "A_v_cache": _A_in["v_cache"],
        "A_wq": _A_in["wq"],
        "A_wo": _A_in["wo"],
        "B_x": _B_in["x"],
        "B_c_kv": _B_in["c_kv"],
        "B_w_q": _B_in["w_q"],
        "B_w_uk": _B_in["w_uk"],
        "B_w_uv": _B_in["w_uv"],
        "B_w_o": _B_in["w_o"],
    }

def reference(A_x, A_k_cache, A_v_cache, A_wq, A_wo, B_x, B_c_kv, B_w_q, B_w_uk, B_w_uv, B_w_o):
    def _A_ref(x, k_cache, v_cache, wq, wo):
        B, Sq, D = x.shape
        Hq, Dh = 32, 128
        Hkv, Sk = k_cache.shape[1], k_cache.shape[2]
        W = min(4096, max(256, Sk // 4))
        rep = Hq // Hkv
        q = (lambda x, *d: x.permute(*d))((x @ wq).reshape(B, Sq, Hq, Dh), 0, 2, 1, 3)
        k = (lambda x, n, axis: torch.repeat_interleave(x, n, dim=axis))(k_cache[:, :, Sk - W:, :], rep, axis=1)
        v = (lambda x, n, axis: torch.repeat_interleave(x, n, dim=axis))(v_cache[:, :, Sk - W:, :], rep, axis=1)
        scores = torch.einsum("bhqd,bhkd->bhqk", q, k) * (Dh ** -0.5)
        p = _softmax(scores, axis=-1)
        o = torch.einsum("bhqk,bhkd->bhqd", p, v)
        return (lambda x, *d: x.permute(*d))(o, 0, 2, 1, 3).reshape(B, Sq, Hq * Dh) @ wo

    def _B_ref(x, c_kv, w_q, w_uk, w_uv, w_o):
        B, Sq, M = x.shape[0], x.shape[1], x.shape[2]
        Sk = c_kv.shape[1]
        H, D = w_q.shape[1], w_q.shape[2]
        q = torch.einsum("bqm,mhd->bhqd", x, w_q)
        k = torch.einsum("bkc,chd->bhkd", c_kv, w_uk)
        v = torch.einsum("bkc,chd->bhkd", c_kv, w_uv)
        scores = torch.einsum("bhqd,bhkd->bhqk", q, k) * (D ** -0.5)
        off = Sk - Sq
        qi = torch.arange(Sq)[:, None]
        kj = torch.arange(Sk)[None, :]
        cmask = kj <= (qi + off)
        scores = torch.where(cmask[None, None], scores, -1e9)
        p = _softmax(scores, axis=-1)
        ctx = torch.einsum("bhqk,bhkd->bhqd", p, v)
        return torch.einsum("bhqd,hdm->bqm", ctx, w_o)

    a = _A_ref(A_x, A_k_cache, A_v_cache, A_wq, A_wo)
    b = _B_ref(B_x, B_c_kv, B_w_q, B_w_uk, B_w_uv, B_w_o)
    return torch.concatenate([a, b], axis=-1)
```

```asm
; @launch kernel=k1q_kernel grid=(192,1,1) block=(256,1,1) lds=20480
; @launch kernel=k2att_kernel grid=(256,1,1) block=(256,1,1) lds=114688
; @launch kernel=k3prj_kernel grid=(256,1,1) block=(256,1,1) lds=36864
; @launch kernel=k4fin_kernel grid=(16,1,1) block=(256,1,1) lds=4096
.amdgcn_target "amdgcn-amd-amdhsa--gfx950"
.text
.globl k1q_kernel
.p2align 8
.type k1q_kernel,@function
k1q_kernel:
    s_cmp_ge_u32 s2, 192
    s_cbranch_scc1 K1_EXIT
    s_load_dwordx2 s[4:5], s[0:1], 104
    s_cmp_ge_u32 s2, 128
    s_cbranch_scc1 K1_A
    s_load_dwordx2 s[6:7], s[0:1], 40
    s_load_dwordx2 s[8:9], s[0:1], 56
    s_load_dwordx2 s[10:11], s[0:1], 64
    s_and_b32 s12, s2, 31
    s_lshr_b32 s13, s2, 5
    s_lshl_b32 s14, s12, 8
    v_lshrrev_b32 v1, 4, v0
    v_and_b32 v2, 15, v0
    v_lshlrev_b32 v3, 18, v1
    v_lshlrev_b32 v4, 4, v2
    v_add3_u32 v3, v3, v4, s14
    v_lshlrev_b32 v5, 6, v1
    v_and_b32 v6, 63, v0
    v_lshrrev_b32 v7, 6, v0
    v_and_b32 v8, 15, v6
    v_lshrrev_b32 v9, 4, v6
    s_lshl_b32 s15, s13, 7
    v_lshlrev_b32 v10, 5, v7
    v_add3_u32 v10, v10, v8, s15
    v_lshlrev_b32 v10, 13, v10
    v_lshlrev_b32 v11, 4, v9
    v_add3_u32 v10, v10, v11, s14
    v_add_u32 v11, 0x20000, v10
    s_waitcnt lgkmcnt(0)
    global_load_dwordx4 v[192:195], v5, s[6:7] offset:0
    global_load_dwordx4 v[196:199], v5, s[6:7] offset:16
    global_load_dwordx4 v[200:203], v5, s[6:7] offset:32
    global_load_dwordx4 v[204:207], v5, s[6:7] offset:48
    global_load_dwordx4 v[208:211], v5, s[6:7] offset:1024
    global_load_dwordx4 v[212:215], v5, s[6:7] offset:1040
    global_load_dwordx4 v[216:219], v5, s[6:7] offset:1056
    global_load_dwordx4 v[220:223], v5, s[6:7] offset:1072
    global_load_dwordx4 v[64:67], v3, s[8:9]
    v_add_u32 v3, 0x2000, v3
    global_load_dwordx4 v[68:71], v3, s[8:9]
    v_add_u32 v3, 0x2000, v3
    global_load_dwordx4 v[72:75], v3, s[8:9]
    v_add_u32 v3, 0x2000, v3
    global_load_dwordx4 v[76:79], v3, s[8:9]
    v_add_u32 v3, 0x2000, v3
    global_load_dwordx4 v[80:83], v3, s[8:9]
    v_add_u32 v3, 0x2000, v3
    global_load_dwordx4 v[84:87], v3, s[8:9]
    v_add_u32 v3, 0x2000, v3
    global_load_dwordx4 v[88:91], v3, s[8:9]
    v_add_u32 v3, 0x2000, v3
    global_load_dwordx4 v[92:95], v3, s[8:9]
    v_add_u32 v3, 0x2000, v3
    global_load_dwordx4 v[96:99], v3, s[8:9]
    v_add_u32 v3, 0x2000, v3
    global_load_dwordx4 v[100:103], v3, s[8:9]
    v_add_u32 v3, 0x2000, v3
    global_load_dwordx4 v[104:107], v3, s[8:9]
    v_add_u32 v3, 0x2000, v3
    global_load_dwordx4 v[108:111], v3, s[8:9]
    v_add_u32 v3, 0x2000, v3
    global_load_dwordx4 v[112:115], v3, s[8:9]
    v_add_u32 v3, 0x2000, v3
    global_load_dwordx4 v[116:119], v3, s[8:9]
    v_add_u32 v3, 0x2000, v3
    global_load_dwordx4 v[120:123], v3, s[8:9]
    v_add_u32 v3, 0x2000, v3
    global_load_dwordx4 v[124:127], v3, s[8:9]
    v_add_u32 v3, 0x2000, v3
    global_load_dwordx4 v[128:131], v3, s[8:9]
    v_add_u32 v3, 0x2000, v3
    global_load_dwordx4 v[132:135], v3, s[8:9]
    v_add_u32 v3, 0x2000, v3
    global_load_dwordx4 v[136:139], v3, s[8:9]
    v_add_u32 v3, 0x2000, v3
    global_load_dwordx4 v[140:143], v3, s[8:9]
    v_add_u32 v3, 0x2000, v3
    global_load_dwordx4 v[144:147], v3, s[8:9]
    v_add_u32 v3, 0x2000, v3
    global_load_dwordx4 v[148:151], v3, s[8:9]
    v_add_u32 v3, 0x2000, v3
    global_load_dwordx4 v[152:155], v3, s[8:9]
    v_add_u32 v3, 0x2000, v3
    global_load_dwordx4 v[156:159], v3, s[8:9]
    v_add_u32 v3, 0x2000, v3
    global_load_dwordx4 v[160:163], v3, s[8:9]
    v_add_u32 v3, 0x2000, v3
    global_load_dwordx4 v[164:167], v3, s[8:9]
    v_add_u32 v3, 0x2000, v3
    global_load_dwordx4 v[168:171], v3, s[8:9]
    v_add_u32 v3, 0x2000, v3
    global_load_dwordx4 v[172:175], v3, s[8:9]
    v_add_u32 v3, 0x2000, v3
    global_load_dwordx4 v[176:179], v3, s[8:9]
    v_add_u32 v3, 0x2000, v3
    global_load_dwordx4 v[180:183], v3, s[8:9]
    v_add_u32 v3, 0x2000, v3
    global_load_dwordx4 v[184:187], v3, s[8:9]
    v_add_u32 v3, 0x2000, v3
    global_load_dwordx4 v[188:191], v3, s[8:9]
    v_add_u32 v3, 0x2000, v3
    global_load_dwordx4 v[224:227], v10, s[10:11] offset:0
    global_load_dwordx4 v[228:231], v10, s[10:11] offset:64
    global_load_dwordx4 v[232:235], v10, s[10:11] offset:128
    global_load_dwordx4 v[236:239], v10, s[10:11] offset:192
    global_load_dwordx4 v[240:243], v11, s[10:11] offset:0
    global_load_dwordx4 v[244:247], v11, s[10:11] offset:64
    global_load_dwordx4 v[248:251], v11, s[10:11] offset:128
    global_load_dwordx4 v[252:255], v11, s[10:11] offset:192
    v_mov_b32 v16, 0
    v_mov_b32 v17, 0
    v_mov_b32 v18, 0
    v_mov_b32 v19, 0
    v_mov_b32 v20, 0
    v_mov_b32 v21, 0
    v_mov_b32 v22, 0
    v_mov_b32 v23, 0
    v_mov_b32 v24, 0
    v_mov_b32 v25, 0
    v_mov_b32 v26, 0
    v_mov_b32 v27, 0
    v_mov_b32 v28, 0
    v_mov_b32 v29, 0
    v_mov_b32 v30, 0
    v_mov_b32 v31, 0
    s_waitcnt vmcnt(39)
    v_lshlrev_b32 v32, 16, v64
    v_and_b32 v33, 0xffff0000, v64
    v_lshlrev_b32 v34, 16, v65
    v_and_b32 v35, 0xffff0000, v65
    v_lshlrev_b32 v36, 16, v66
    v_and_b32 v37, 0xffff0000, v66
    v_lshlrev_b32 v38, 16, v67
    v_and_b32 v39, 0xffff0000, v67
    v_lshlrev_b32 v40, 16, v192
    v_lshlrev_b32 v41, 16, v208
    v_fmac_f32 v16, v32, v40
    v_fmac_f32 v24, v32, v41
    v_fmac_f32 v17, v33, v40
    v_fmac_f32 v25, v33, v41
    v_fmac_f32 v18, v34, v40
    v_fmac_f32 v26, v34, v41
    v_fmac_f32 v19, v35, v40
    v_fmac_f32 v27, v35, v41
    v_fmac_f32 v20, v36, v40
    v_fmac_f32 v28, v36, v41
    v_fmac_f32 v21, v37, v40
    v_fmac_f32 v29, v37, v41
    v_fmac_f32 v22, v38, v40
    v_fmac_f32 v30, v38, v41
    v_fmac_f32 v23, v39, v40
    v_fmac_f32 v31, v39, v41
    s_waitcnt vmcnt(38)
    v_lshlrev_b32 v32, 16, v68
    v_and_b32 v33, 0xffff0000, v68
    v_lshlrev_b32 v34, 16, v69
    v_and_b32 v35, 0xffff0000, v69
    v_lshlrev_b32 v36, 16, v70
    v_and_b32 v37, 0xffff0000, v70
    v_lshlrev_b32 v38, 16, v71
    v_and_b32 v39, 0xffff0000, v71
    v_and_b32 v40, 0xffff0000, v192
    v_and_b32 v41, 0xffff0000, v208
    v_fmac_f32 v16, v32, v40
    v_fmac_f32 v24, v32, v41
    v_fmac_f32 v17, v33, v40
    v_fmac_f32 v25, v33, v41
    v_fmac_f32 v18, v34, v40
    v_fmac_f32 v26, v34, v41
    v_fmac_f32 v19, v35, v40
    v_fmac_f32 v27, v35, v41
    v_fmac_f32 v20, v36, v40
    v_fmac_f32 v28, v36, v41
    v_fmac_f32 v21, v37, v40
    v_fmac_f32 v29, v37, v41
    v_fmac_f32 v22, v38, v40
    v_fmac_f32 v30, v38, v41
    v_fmac_f32 v23, v39, v40
    v_fmac_f32 v31, v39, v41
    s_waitcnt vmcnt(37)
    v_lshlrev_b32 v32, 16, v72
    v_and_b32 v33, 0xffff0000, v72
    v_lshlrev_b32 v34, 16, v73
    v_and_b32 v35, 0xffff0000, v73
    v_lshlrev_b32 v36, 16, v74
    v_and_b32 v37, 0xffff0000, v74
    v_lshlrev_b32 v38, 16, v75
    v_and_b32 v39, 0xffff0000, v75
    v_lshlrev_b32 v40, 16, v193
    v_lshlrev_b32 v41, 16, v209
    v_fmac_f32 v16, v32, v40
    v_fmac_f32 v24, v32, v41
    v_fmac_f32 v17, v33, v40
    v_fmac_f32 v25, v33, v41
    v_fmac_f32 v18, v34, v40
    v_fmac_f32 v26, v34, v41
    v_fmac_f32 v19, v35, v40
    v_fmac_f32 v27, v35, v41
    v_fmac_f32 v20, v36, v40
    v_fmac_f32 v28, v36, v41
    v_fmac_f32 v21, v37, v40
    v_fmac_f32 v29, v37, v41
    v_fmac_f32 v22, v38, v40
    v_fmac_f32 v30, v38, v41
    v_fmac_f32 v23, v39, v40
    v_fmac_f32 v31, v39, v41
    s_waitcnt vmcnt(36)
    v_lshlrev_b32 v32, 16, v76
    v_and_b32 v33, 0xffff0000, v76
    v_lshlrev_b32 v34, 16, v77
    v_and_b32 v35, 0xffff0000, v77
    v_lshlrev_b32 v36, 16, v78
    v_and_b32 v37, 0xffff0000, v78
    v_lshlrev_b32 v38, 16, v79
    v_and_b32 v39, 0xffff0000, v79
    v_and_b32 v40, 0xffff0000, v193
    v_and_b32 v41, 0xffff0000, v209
    v_fmac_f32 v16, v32, v40
    v_fmac_f32 v24, v32, v41
    v_fmac_f32 v17, v33, v40
    v_fmac_f32 v25, v33, v41
    v_fmac_f32 v18, v34, v40
    v_fmac_f32 v26, v34, v41
    v_fmac_f32 v19, v35, v40
    v_fmac_f32 v27, v35, v41
    v_fmac_f32 v20, v36, v40
    v_fmac_f32 v28, v36, v41
    v_fmac_f32 v21, v37, v40
    v_fmac_f32 v29, v37, v41
    v_fmac_f32 v22, v38, v40
    v_fmac_f32 v30, v38, v41
    v_fmac_f32 v23, v39, v40
    v_fmac_f32 v31, v39, v41
    s_waitcnt vmcnt(35)
    v_lshlrev_b32 v32, 16, v80
    v_and_b32 v33, 0xffff0000, v80
    v_lshlrev_b32 v34, 16, v81
    v_and_b32 v35, 0xffff0000, v81
    v_lshlrev_b32 v36, 16, v82
    v_and_b32 v37, 0xffff0000, v82
    v_lshlrev_b32 v38, 16, v83
    v_and_b32 v39, 0xffff0000, v83
    v_lshlrev_b32 v40, 16, v194
    v_lshlrev_b32 v41, 16, v210
    v_fmac_f32 v16, v32, v40
    v_fmac_f32 v24, v32, v41
    v_fmac_f32 v17, v33, v40
    v_fmac_f32 v25, v33, v41
    v_fmac_f32 v18, v34, v40
    v_fmac_f32 v26, v34, v41
    v_fmac_f32 v19, v35, v40
    v_fmac_f32 v27, v35, v41
    v_fmac_f32 v20, v36, v40
    v_fmac_f32 v28, v36, v41
    v_fmac_f32 v21, v37, v40
    v_fmac_f32 v29, v37, v41
    v_fmac_f32 v22, v38, v40
    v_fmac_f32 v30, v38, v41
    v_fmac_f32 v23, v39, v40
    v_fmac_f32 v31, v39, v41
    s_waitcnt vmcnt(34)
    v_lshlrev_b32 v32, 16, v84
    v_and_b32 v33, 0xffff0000, v84
    v_lshlrev_b32 v34, 16, v85
    v_and_b32 v35, 0xffff0000, v85
    v_lshlrev_b32 v36, 16, v86
    v_and_b32 v37, 0xffff0000, v86
    v_lshlrev_b32 v38, 16, v87
    v_and_b32 v39, 0xffff0000, v87
    v_and_b32 v40, 0xffff0000, v194
    v_and_b32 v41, 0xffff0000, v210
    v_fmac_f32 v16, v32, v40
    v_fmac_f32 v24, v32, v41
    v_fmac_f32 v17, v33, v40
    v_fmac_f32 v25, v33, v41
    v_fmac_f32 v18, v34, v40
    v_fmac_f32 v26, v34, v41
    v_fmac_f32 v19, v35, v40
    v_fmac_f32 v27, v35, v41
    v_fmac_f32 v20, v36, v40
    v_fmac_f32 v28, v36, v41
    v_fmac_f32 v21, v37, v40
    v_fmac_f32 v29, v37, v41
    v_fmac_f32 v22, v38, v40
    v_fmac_f32 v30, v38, v41
    v_fmac_f32 v23, v39, v40
    v_fmac_f32 v31, v39, v41
    s_waitcnt vmcnt(33)
    v_lshlrev_b32 v32, 16, v88
    v_and_b32 v33, 0xffff0000, v88
    v_lshlrev_b32 v34, 16, v89
    v_and_b32 v35, 0xffff0000, v89
    v_lshlrev_b32 v36, 16, v90
    v_and_b32 v37, 0xffff0000, v90
    v_lshlrev_b32 v38, 16, v91
    v_and_b32 v39, 0xffff0000, v91
    v_lshlrev_b32 v40, 16, v195
    v_lshlrev_b32 v41, 16, v211
    v_fmac_f32 v16, v32, v40
    v_fmac_f32 v24, v32, v41
    v_fmac_f32 v17, v33, v40
    v_fmac_f32 v25, v33, v41
    v_fmac_f32 v18, v34, v40
    v_fmac_f32 v26, v34, v41
    v_fmac_f32 v19, v35, v40
    v_fmac_f32 v27, v35, v41
    v_fmac_f32 v20, v36, v40
    v_fmac_f32 v28, v36, v41
    v_fmac_f32 v21, v37, v40
    v_fmac_f32 v29, v37, v41
    v_fmac_f32 v22, v38, v40
    v_fmac_f32 v30, v38, v41
    v_fmac_f32 v23, v39, v40
    v_fmac_f32 v31, v39, v41
    s_waitcnt vmcnt(32)
    v_lshlrev_b32 v32, 16, v92
    v_and_b32 v33, 0xffff0000, v92
    v_lshlrev_b32 v34, 16, v93
    v_and_b32 v35, 0xffff0000, v93
    v_lshlrev_b32 v36, 16, v94
    v_and_b32 v37, 0xffff0000, v94
    v_lshlrev_b32 v38, 16, v95
    v_and_b32 v39, 0xffff0000, v95
    v_and_b32 v40, 0xffff0000, v195
    v_and_b32 v41, 0xffff0000, v211
    v_fmac_f32 v16, v32, v40
    v_fmac_f32 v24, v32, v41
    v_fmac_f32 v17, v33, v40
    v_fmac_f32 v25, v33, v41
    v_fmac_f32 v18, v34, v40
    v_fmac_f32 v26, v34, v41
    v_fmac_f32 v19, v35, v40
    v_fmac_f32 v27, v35, v41
    v_fmac_f32 v20, v36, v40
    v_fmac_f32 v28, v36, v41
    v_fmac_f32 v21, v37, v40
    v_fmac_f32 v29, v37, v41
    v_fmac_f32 v22, v38, v40
    v_fmac_f32 v30, v38, v41
    v_fmac_f32 v23, v39, v40
    v_fmac_f32 v31, v39, v41
    s_waitcnt vmcnt(31)
    v_lshlrev_b32 v32, 16, v96
    v_and_b32 v33, 0xffff0000, v96
    v_lshlrev_b32 v34, 16, v97
    v_and_b32 v35, 0xffff0000, v97
    v_lshlrev_b32 v36, 16, v98
    v_and_b32 v37, 0xffff0000, v98
    v_lshlrev_b32 v38, 16, v99
    v_and_b32 v39, 0xffff0000, v99
    v_lshlrev_b32 v40, 16, v196
    v_lshlrev_b32 v41, 16, v212
    v_fmac_f32 v16, v32, v40
    v_fmac_f32 v24, v32, v41
    v_fmac_f32 v17, v33, v40
    v_fmac_f32 v25, v33, v41
    v_fmac_f32 v18, v34, v40
    v_fmac_f32 v26, v34, v41
    v_fmac_f32 v19, v35, v40
    v_fmac_f32 v27, v35, v41
    v_fmac_f32 v20, v36, v40
    v_fmac_f32 v28, v36, v41
    v_fmac_f32 v21, v37, v40
    v_fmac_f32 v29, v37, v41
    v_fmac_f32 v22, v38, v40
    v_fmac_f32 v30, v38, v41
    v_fmac_f32 v23, v39, v40
    v_fmac_f32 v31, v39, v41
    s_waitcnt vmcnt(30)
    v_lshlrev_b32 v32, 16, v100
    v_and_b32 v33, 0xffff0000, v100
    v_lshlrev_b32 v34, 16, v101
    v_and_b32 v35, 0xffff0000, v101
    v_lshlrev_b32 v36, 16, v102
    v_and_b32 v37, 0xffff0000, v102
    v_lshlrev_b32 v38, 16, v103
    v_and_b32 v39, 0xffff0000, v103
    v_and_b32 v40, 0xffff0000, v196
    v_and_b32 v41, 0xffff0000, v212
    v_fmac_f32 v16, v32, v40
    v_fmac_f32 v24, v32, v41
    v_fmac_f32 v17, v33, v40
    v_fmac_f32 v25, v33, v41
    v_fmac_f32 v18, v34, v40
    v_fmac_f32 v26, v34, v41
    v_fmac_f32 v19, v35, v40
    v_fmac_f32 v27, v35, v41
    v_fmac_f32 v20, v36, v40
    v_fmac_f32 v28, v36, v41
    v_fmac_f32 v21, v37, v40
    v_fmac_f32 v29, v37, v41
    v_fmac_f32 v22, v38, v40
    v_fmac_f32 v30, v38, v41
    v_fmac_f32 v23, v39, v40
    v_fmac_f32 v31, v39, v41
    s_waitcnt vmcnt(29)
    v_lshlrev_b32 v32, 16, v104
    v_and_b32 v33, 0xffff0000, v104
    v_lshlrev_b32 v34, 16, v105
    v_and_b32 v35, 0xffff0000, v105
    v_lshlrev_b32 v36, 16, v106
    v_and_b32 v37, 0xffff0000, v106
    v_lshlrev_b32 v38, 16, v107
    v_and_b32 v39, 0xffff0000, v107
    v_lshlrev_b32 v40, 16, v197
    v_lshlrev_b32 v41, 16, v213
    v_fmac_f32 v16, v32, v40
    v_fmac_f32 v24, v32, v41
    v_fmac_f32 v17, v33, v40
    v_fmac_f32 v25, v33, v41
    v_fmac_f32 v18, v34, v40
    v_fmac_f32 v26, v34, v41
    v_fmac_f32 v19, v35, v40
    v_fmac_f32 v27, v35, v41
    v_fmac_f32 v20, v36, v40
    v_fmac_f32 v28, v36, v41
    v_fmac_f32 v21, v37, v40
    v_fmac_f32 v29, v37, v41
    v_fmac_f32 v22, v38, v40
    v_fmac_f32 v30, v38, v41
    v_fmac_f32 v23, v39, v40
    v_fmac_f32 v31, v39, v41
    s_waitcnt vmcnt(28)
    v_lshlrev_b32 v32, 16, v108
    v_and_b32 v33, 0xffff0000, v108
    v_lshlrev_b32 v34, 16, v109
    v_and_b32 v35, 0xffff0000, v109
    v_lshlrev_b32 v36, 16, v110
    v_and_b32 v37, 0xffff0000, v110
    v_lshlrev_b32 v38, 16, v111
    v_and_b32 v39, 0xffff0000, v111
    v_and_b32 v40, 0xffff0000, v197
    v_and_b32 v41, 0xffff0000, v213
    v_fmac_f32 v16, v32, v40
    v_fmac_f32 v24, v32, v41
    v_fmac_f32 v17, v33, v40
    v_fmac_f32 v25, v33, v41
    v_fmac_f32 v18, v34, v40
    v_fmac_f32 v26, v34, v41
    v_fmac_f32 v19, v35, v40
    v_fmac_f32 v27, v35, v41
    v_fmac_f32 v20, v36, v40
    v_fmac_f32 v28, v36, v41
    v_fmac_f32 v21, v37, v40
    v_fmac_f32 v29, v37, v41
    v_fmac_f32 v22, v38, v40
    v_fmac_f32 v30, v38, v41
    v_fmac_f32 v23, v39, v40
    v_fmac_f32 v31, v39, v41
    s_waitcnt vmcnt(27)
    v_lshlrev_b32 v32, 16, v112
    v_and_b32 v33, 0xffff0000, v112
    v_lshlrev_b32 v34, 16, v113
    v_and_b32 v35, 0xffff0000, v113
    v_lshlrev_b32 v36, 16, v114
    v_and_b32 v37, 0xffff0000, v114
    v_lshlrev_b32 v38, 16, v115
    v_and_b32 v39, 0xffff0000, v115
    v_lshlrev_b32 v40, 16, v198
    v_lshlrev_b32 v41, 16, v214
    v_fmac_f32 v16, v32, v40
    v_fmac_f32 v24, v32, v41
    v_fmac_f32 v17, v33, v40
    v_fmac_f32 v25, v33, v41
    v_fmac_f32 v18, v34, v40
    v_fmac_f32 v26, v34, v41
    v_fmac_f32 v19, v35, v40
    v_fmac_f32 v27, v35, v41
    v_fmac_f32 v20, v36, v40
    v_fmac_f32 v28, v36, v41
    v_fmac_f32 v21, v37, v40
    v_fmac_f32 v29, v37, v41
    v_fmac_f32 v22, v38, v40
    v_fmac_f32 v30, v38, v41
    v_fmac_f32 v23, v39, v40
    v_fmac_f32 v31, v39, v41
    s_waitcnt vmcnt(26)
    v_lshlrev_b32 v32, 16, v116
    v_and_b32 v33, 0xffff0000, v116
    v_lshlrev_b32 v34, 16, v117
    v_and_b32 v35, 0xffff0000, v117
    v_lshlrev_b32 v36, 16, v118
    v_and_b32 v37, 0xffff0000, v118
    v_lshlrev_b32 v38, 16, v119
    v_and_b32 v39, 0xffff0000, v119
    v_and_b32 v40, 0xffff0000, v198
    v_and_b32 v41, 0xffff0000, v214
    v_fmac_f32 v16, v32, v40
    v_fmac_f32 v24, v32, v41
    v_fmac_f32 v17, v33, v40
    v_fmac_f32 v25, v33, v41
    v_fmac_f32 v18, v34, v40
    v_fmac_f32 v26, v34, v41
    v_fmac_f32 v19, v35, v40
    v_fmac_f32 v27, v35, v41
    v_fmac_f32 v20, v36, v40
    v_fmac_f32 v28, v36, v41
    v_fmac_f32 v21, v37, v40
    v_fmac_f32 v29, v37, v41
    v_fmac_f32 v22, v38, v40
    v_fmac_f32 v30, v38, v41
    v_fmac_f32 v23, v39, v40
    v_fmac_f32 v31, v39, v41
    s_waitcnt vmcnt(25)
    v_lshlrev_b32 v32, 16, v120
    v_and_b32 v33, 0xffff0000, v120
    v_lshlrev_b32 v34, 16, v121
    v_and_b32 v35, 0xffff0000, v121
    v_lshlrev_b32 v36, 16, v122
    v_and_b32 v37, 0xffff0000, v122
    v_lshlrev_b32 v38, 16, v123
    v_and_b32 v39, 0xffff0000, v123
    v_lshlrev_b32 v40, 16, v199
    v_lshlrev_b32 v41, 16, v215
    v_fmac_f32 v16, v32, v40
    v_fmac_f32 v24, v32, v41
    v_fmac_f32 v17, v33, v40
    v_fmac_f32 v25, v33, v41
    v_fmac_f32 v18, v34, v40
    v_fmac_f32 v26, v34, v41
    v_fmac_f32 v19, v35, v40
    v_fmac_f32 v27, v35, v41
    v_fmac_f32 v20, v36, v40
    v_fmac_f32 v28, v36, v41
    v_fmac_f32 v21, v37, v40
    v_fmac_f32 v29, v37, v41
    v_fmac_f32 v22, v38, v40
    v_fmac_f32 v30, v38, v41
    v_fmac_f32 v23, v39, v40
    v_fmac_f32 v31, v39, v41
    s_waitcnt vmcnt(24)
    v_lshlrev_b32 v32, 16, v124
    v_and_b32 v33, 0xffff0000, v124
    v_lshlrev_b32 v34, 16, v125
    v_and_b32 v35, 0xffff0000, v125
    v_lshlrev_b32 v36, 16, v126
    v_and_b32 v37, 0xffff0000, v126
    v_lshlrev_b32 v38, 16, v127
    v_and_b32 v39, 0xffff0000, v127
    v_and_b32 v40, 0xffff0000, v199
    v_and_b32 v41, 0xffff0000, v215
    v_fmac_f32 v16, v32, v40
    v_fmac_f32 v24, v32, v41
    v_fmac_f32 v17, v33, v40
    v_fmac_f32 v25, v33, v41
    v_fmac_f32 v18, v34, v40
    v_fmac_f32 v26, v34, v41
    v_fmac_f32 v19, v35, v40
    v_fmac_f32 v27, v35, v41
    v_fmac_f32 v20, v36, v40
    v_fmac_f32 v28, v36, v41
    v_fmac_f32 v21, v37, v40
    v_fmac_f32 v29, v37, v41
    v_fmac_f32 v22, v38, v40
    v_fmac_f32 v30, v38, v41
    v_fmac_f32 v23, v39, v40
    v_fmac_f32 v31, v39, v41
    s_waitcnt vmcnt(23)
    v_lshlrev_b32 v32, 16, v128
    v_and_b32 v33, 0xffff0000, v128
    v_lshlrev_b32 v34, 16, v129
    v_and_b32 v35, 0xffff0000, v129
    v_lshlrev_b32 v36, 16, v130
    v_and_b32 v37, 0xffff0000, v130
    v_lshlrev_b32 v38, 16, v131
    v_and_b32 v39, 0xffff0000, v131
    v_lshlrev_b32 v40, 16, v200
    v_lshlrev_b32 v41, 16, v216
    v_fmac_f32 v16, v32, v40
    v_fmac_f32 v24, v32, v41
    v_fmac_f32 v17, v33, v40
    v_fmac_f32 v25, v33, v41
    v_fmac_f32 v18, v34, v40
    v_fmac_f32 v26, v34, v41
    v_fmac_f32 v19, v35, v40
    v_fmac_f32 v27, v35, v41
    v_fmac_f32 v20, v36, v40
    v_fmac_f32 v28, v36, v41
    v_fmac_f32 v21, v37, v40
    v_fmac_f32 v29, v37, v41
    v_fmac_f32 v22, v38, v40
    v_fmac_f32 v30, v38, v41
    v_fmac_f32 v23, v39, v40
    v_fmac_f32 v31, v39, v41
    s_waitcnt vmcnt(22)
    v_lshlrev_b32 v32, 16, v132
    v_and_b32 v33, 0xffff0000, v132
    v_lshlrev_b32 v34, 16, v133
    v_and_b32 v35, 0xffff0000, v133
    v_lshlrev_b32 v36, 16, v134
    v_and_b32 v37, 0xffff0000, v134
    v_lshlrev_b32 v38, 16, v135
    v_and_b32 v39, 0xffff0000, v135
    v_and_b32 v40, 0xffff0000, v200
    v_and_b32 v41, 0xffff0000, v216
    v_fmac_f32 v16, v32, v40
    v_fmac_f32 v24, v32, v41
    v_fmac_f32 v17, v33, v40
    v_fmac_f32 v25, v33, v41
    v_fmac_f32 v18, v34, v40
    v_fmac_f32 v26, v34, v41
    v_fmac_f32 v19, v35, v40
    v_fmac_f32 v27, v35, v41
    v_fmac_f32 v20, v36, v40
    v_fmac_f32 v28, v36, v41
    v_fmac_f32 v21, v37, v40
    v_fmac_f32 v29, v37, v41
    v_fmac_f32 v22, v38, v40
    v_fmac_f32 v30, v38, v41
    v_fmac_f32 v23, v39, v40
    v_fmac_f32 v31, v39, v41
    s_waitcnt vmcnt(21)
    v_lshlrev_b32 v32, 16, v136
    v_and_b32 v33, 0xffff0000, v136
    v_lshlrev_b32 v34, 16, v137
    v_and_b32 v35, 0xffff0000, v137
    v_lshlrev_b32 v36, 16, v138
    v_and_b32 v37, 0xffff0000, v138
    v_lshlrev_b32 v38, 16, v139
    v_and_b32 v39, 0xffff0000, v139
    v_lshlrev_b32 v40, 16, v201
    v_lshlrev_b32 v41, 16, v217
    v_fmac_f32 v16, v32, v40
    v_fmac_f32 v24, v32, v41
    v_fmac_f32 v17, v33, v40
    v_fmac_f32 v25, v33, v41
    v_fmac_f32 v18, v34, v40
    v_fmac_f32 v26, v34, v41
    v_fmac_f32 v19, v35, v40
    v_fmac_f32 v27, v35, v41
    v_fmac_f32 v20, v36, v40
    v_fmac_f32 v28, v36, v41
    v_fmac_f32 v21, v37, v40
    v_fmac_f32 v29, v37, v41
    v_fmac_f32 v22, v38, v40
    v_fmac_f32 v30, v38, v41
    v_fmac_f32 v23, v39, v40
    v_fmac_f32 v31, v39, v41
    s_waitcnt vmcnt(20)
    v_lshlrev_b32 v32, 16, v140
    v_and_b32 v33, 0xffff0000, v140
    v_lshlrev_b32 v34, 16, v141
    v_and_b32 v35, 0xffff0000, v141
    v_lshlrev_b32 v36, 16, v142
    v_and_b32 v37, 0xffff0000, v142
    v_lshlrev_b32 v38, 16, v143
    v_and_b32 v39, 0xffff0000, v143
    v_and_b32 v40, 0xffff0000, v201
    v_and_b32 v41, 0xffff0000, v217
    v_fmac_f32 v16, v32, v40
    v_fmac_f32 v24, v32, v41
    v_fmac_f32 v17, v33, v40
    v_fmac_f32 v25, v33, v41
    v_fmac_f32 v18, v34, v40
    v_fmac_f32 v26, v34, v41
    v_fmac_f32 v19, v35, v40
    v_fmac_f32 v27, v35, v41
    v_fmac_f32 v20, v36, v40
    v_fmac_f32 v28, v36, v41
    v_fmac_f32 v21, v37, v40
    v_fmac_f32 v29, v37, v41
    v_fmac_f32 v22, v38, v40
    v_fmac_f32 v30, v38, v41
    v_fmac_f32 v23, v39, v40
    v_fmac_f32 v31, v39, v41
    s_waitcnt vmcnt(19)
    v_lshlrev_b32 v32, 16, v144
    v_and_b32 v33, 0xffff0000, v144
    v_lshlrev_b32 v34, 16, v145
    v_and_b32 v35, 0xffff0000, v145
    v_lshlrev_b32 v36, 16, v146
    v_and_b32 v37, 0xffff0000, v146
    v_lshlrev_b32 v38, 16, v147
    v_and_b32 v39, 0xffff0000, v147
    v_lshlrev_b32 v40, 16, v202
    v_lshlrev_b32 v41, 16, v218
    v_fmac_f32 v16, v32, v40
    v_fmac_f32 v24, v32, v41
    v_fmac_f32 v17, v33, v40
    v_fmac_f32 v25, v33, v41
    v_fmac_f32 v18, v34, v40
    v_fmac_f32 v26, v34, v41
    v_fmac_f32 v19, v35, v40
    v_fmac_f32 v27, v35, v41
    v_fmac_f32 v20, v36, v40
    v_fmac_f32 v28, v36, v41
    v_fmac_f32 v21, v37, v40
    v_fmac_f32 v29, v37, v41
    v_fmac_f32 v22, v38, v40
    v_fmac_f32 v30, v38, v41
    v_fmac_f32 v23, v39, v40
    v_fmac_f32 v31, v39, v41
    s_waitcnt vmcnt(18)
    v_lshlrev_b32 v32, 16, v148
    v_and_b32 v33, 0xffff0000, v148
    v_lshlrev_b32 v34, 16, v149
    v_and_b32 v35, 0xffff0000, v149
    v_lshlrev_b32 v36, 16, v150
    v_and_b32 v37, 0xffff0000, v150
    v_lshlrev_b32 v38, 16, v151
    v_and_b32 v39, 0xffff0000, v151
    v_and_b32 v40, 0xffff0000, v202
    v_and_b32 v41, 0xffff0000, v218
    v_fmac_f32 v16, v32, v40
    v_fmac_f32 v24, v32, v41
    v_fmac_f32 v17, v33, v40
    v_fmac_f32 v25, v33, v41
    v_fmac_f32 v18, v34, v40
    v_fmac_f32 v26, v34, v41
    v_fmac_f32 v19, v35, v40
    v_fmac_f32 v27, v35, v41
    v_fmac_f32 v20, v36, v40
    v_fmac_f32 v28, v36, v41
    v_fmac_f32 v21, v37, v40
    v_fmac_f32 v29, v37, v41
    v_fmac_f32 v22, v38, v40
    v_fmac_f32 v30, v38, v41
    v_fmac_f32 v23, v39, v40
    v_fmac_f32 v31, v39, v41
    s_waitcnt vmcnt(17)
    v_lshlrev_b32 v32, 16, v152
    v_and_b32 v33, 0xffff0000, v152
    v_lshlrev_b32 v34, 16, v153
    v_and_b32 v35, 0xffff0000, v153
    v_lshlrev_b32 v36, 16, v154
    v_and_b32 v37, 0xffff0000, v154
    v_lshlrev_b32 v38, 16, v155
    v_and_b32 v39, 0xffff0000, v155
    v_lshlrev_b32 v40, 16, v203
    v_lshlrev_b32 v41, 16, v219
    v_fmac_f32 v16, v32, v40
    v_fmac_f32 v24, v32, v41
    v_fmac_f32 v17, v33, v40
    v_fmac_f32 v25, v33, v41
    v_fmac_f32 v18, v34, v40
    v_fmac_f32 v26, v34, v41
    v_fmac_f32 v19, v35, v40
    v_fmac_f32 v27, v35, v41
    v_fmac_f32 v20, v36, v40
    v_fmac_f32 v28, v36, v41
    v_fmac_f32 v21, v37, v40
    v_fmac_f32 v29, v37, v41
    v_fmac_f32 v22, v38, v40
    v_fmac_f32 v30, v38, v41
    v_fmac_f32 v23, v39, v40
    v_fmac_f32 v31, v39, v41
    s_waitcnt vmcnt(16)
    v_lshlrev_b32 v32, 16, v156
    v_and_b32 v33, 0xffff0000, v156
    v_lshlrev_b32 v34, 16, v157
    v_and_b32 v35, 0xffff0000, v157
    v_lshlrev_b32 v36, 16, v158
    v_and_b32 v37, 0xffff0000, v158
    v_lshlrev_b32 v38, 16, v159
    v_and_b32 v39, 0xffff0000, v159
    v_and_b32 v40, 0xffff0000, v203
    v_and_b32 v41, 0xffff0000, v219
    v_fmac_f32 v16, v32, v40
    v_fmac_f32 v24, v32, v41
    v_fmac_f32 v17, v33, v40
    v_fmac_f32 v25, v33, v41
    v_fmac_f32 v18, v34, v40
    v_fmac_f32 v26, v34, v41
    v_fmac_f32 v19, v35, v40
    v_fmac_f32 v27, v35, v41
    v_fmac_f32 v20, v36, v40
    v_fmac_f32 v28, v36, v41
    v_fmac_f32 v21, v37, v40
    v_fmac_f32 v29, v37, v41
    v_fmac_f32 v22, v38, v40
    v_fmac_f32 v30, v38, v41
    v_fmac_f32 v23, v39, v40
    v_fmac_f32 v31, v39, v41
    s_waitcnt vmcnt(15)
    v_lshlrev_b32 v32, 16, v160
    v_and_b32 v33, 0xffff0000, v160
    v_lshlrev_b32 v34, 16, v161
    v_and_b32 v35, 0xffff0000, v161
    v_lshlrev_b32 v36, 16, v162
    v_and_b32 v37, 0xffff0000, v162
    v_lshlrev_b32 v38, 16, v163
    v_and_b32 v39, 0xffff0000, v163
    v_lshlrev_b32 v40, 16, v204
    v_lshlrev_b32 v41, 16, v220
    v_fmac_f32 v16, v32, v40
    v_fmac_f32 v24, v32, v41
    v_fmac_f32 v17, v33, v40
    v_fmac_f32 v25, v33, v41
    v_fmac_f32 v18, v34, v40
    v_fmac_f32 v26, v34, v41
    v_fmac_f32 v19, v35, v40
    v_fmac_f32 v27, v35, v41
    v_fmac_f32 v20, v36, v40
    v_fmac_f32 v28, v36, v41
    v_fmac_f32 v21, v37, v40
    v_fmac_f32 v29, v37, v41
    v_fmac_f32 v22, v38, v40
    v_fmac_f32 v30, v38, v41
    v_fmac_f32 v23, v39, v40
    v_fmac_f32 v31, v39, v41
    s_waitcnt vmcnt(14)
    v_lshlrev_b32 v32, 16, v164
    v_and_b32 v33, 0xffff0000, v164
    v_lshlrev_b32 v34, 16, v165
    v_and_b32 v35, 0xffff0000, v165
    v_lshlrev_b32 v36, 16, v166
    v_and_b32 v37, 0xffff0000, v166
    v_lshlrev_b32 v38, 16, v167
    v_and_b32 v39, 0xffff0000, v167
    v_and_b32 v40, 0xffff0000, v204
    v_and_b32 v41, 0xffff0000, v220
    v_fmac_f32 v16, v32, v40
    v_fmac_f32 v24, v32, v41
    v_fmac_f32 v17, v33, v40
    v_fmac_f32 v25, v33, v41
    v_fmac_f32 v18, v34, v40
    v_fmac_f32 v26, v34, v41
    v_fmac_f32 v19, v35, v40
    v_fmac_f32 v27, v35, v41
    v_fmac_f32 v20, v36, v40
    v_fmac_f32 v28, v36, v41
    v_fmac_f32 v21, v37, v40
    v_fmac_f32 v29, v37, v41
    v_fmac_f32 v22, v38, v40
    v_fmac_f32 v30, v38, v41
    v_fmac_f32 v23, v39, v40
    v_fmac_f32 v31, v39, v41
    s_waitcnt vmcnt(13)
    v_lshlrev_b32 v32, 16, v168
    v_and_b32 v33, 0xffff0000, v168
    v_lshlrev_b32 v34, 16, v169
    v_and_b32 v35, 0xffff0000, v169
    v_lshlrev_b32 v36, 16, v170
    v_and_b32 v37, 0xffff0000, v170
    v_lshlrev_b32 v38, 16, v171
    v_and_b32 v39, 0xffff0000, v171
    v_lshlrev_b32 v40, 16, v205
    v_lshlrev_b32 v41, 16, v221
    v_fmac_f32 v16, v32, v40
    v_fmac_f32 v24, v32, v41
    v_fmac_f32 v17, v33, v40
    v_fmac_f32 v25, v33, v41
    v_fmac_f32 v18, v34, v40
    v_fmac_f32 v26, v34, v41
    v_fmac_f32 v19, v35, v40
    v_fmac_f32 v27, v35, v41
    v_fmac_f32 v20, v36, v40
    v_fmac_f32 v28, v36, v41
    v_fmac_f32 v21, v37, v40
    v_fmac_f32 v29, v37, v41
    v_fmac_f32 v22, v38, v40
    v_fmac_f32 v30, v38, v41
    v_fmac_f32 v23, v39, v40
    v_fmac_f32 v31, v39, v41
    s_waitcnt vmcnt(12)
    v_lshlrev_b32 v32, 16, v172
    v_and_b32 v33, 0xffff0000, v172
    v_lshlrev_b32 v34, 16, v173
    v_and_b32 v35, 0xffff0000, v173
    v_lshlrev_b32 v36, 16, v174
    v_and_b32 v37, 0xffff0000, v174
    v_lshlrev_b32 v38, 16, v175
    v_and_b32 v39, 0xffff0000, v175
    v_and_b32 v40, 0xffff0000, v205
    v_and_b32 v41, 0xffff0000, v221
    v_fmac_f32 v16, v32, v40
    v_fmac_f32 v24, v32, v41
    v_fmac_f32 v17, v33, v40
    v_fmac_f32 v25, v33, v41
    v_fmac_f32 v18, v34, v40
    v_fmac_f32 v26, v34, v41
    v_fmac_f32 v19, v35, v40
    v_fmac_f32 v27, v35, v41
    v_fmac_f32 v20, v36, v40
    v_fmac_f32 v28, v36, v41
    v_fmac_f32 v21, v37, v40
    v_fmac_f32 v29, v37, v41
    v_fmac_f32 v22, v38, v40
    v_fmac_f32 v30, v38, v41
    v_fmac_f32 v23, v39, v40
    v_fmac_f32 v31, v39, v41
    s_waitcnt vmcnt(11)
    v_lshlrev_b32 v32, 16, v176
    v_and_b32 v33, 0xffff0000, v176
    v_lshlrev_b32 v34, 16, v177
    v_and_b32 v35, 0xffff0000, v177
    v_lshlrev_b32 v36, 16, v178
    v_and_b32 v37, 0xffff0000, v178
    v_lshlrev_b32 v38, 16, v179
    v_and_b32 v39, 0xffff0000, v179
    v_lshlrev_b32 v40, 16, v206
    v_lshlrev_b32 v41, 16, v222
    v_fmac_f32 v16, v32, v40
    v_fmac_f32 v24, v32, v41
    v_fmac_f32 v17, v33, v40
    v_fmac_f32 v25, v33, v41
    v_fmac_f32 v18, v34, v40
    v_fmac_f32 v26, v34, v41
    v_fmac_f32 v19, v35, v40
    v_fmac_f32 v27, v35, v41
    v_fmac_f32 v20, v36, v40
    v_fmac_f32 v28, v36, v41
    v_fmac_f32 v21, v37, v40
    v_fmac_f32 v29, v37, v41
    v_fmac_f32 v22, v38, v40
    v_fmac_f32 v30, v38, v41
    v_fmac_f32 v23, v39, v40
    v_fmac_f32 v31, v39, v41
    s_waitcnt vmcnt(10)
    v_lshlrev_b32 v32, 16, v180
    v_and_b32 v33, 0xffff0000, v180
    v_lshlrev_b32 v34, 16, v181
    v_and_b32 v35, 0xffff0000, v181
    v_lshlrev_b32 v36, 16, v182
    v_and_b32 v37, 0xffff0000, v182
    v_lshlrev_b32 v38, 16, v183
    v_and_b32 v39, 0xffff0000, v183
    v_and_b32 v40, 0xffff0000, v206
    v_and_b32 v41, 0xffff0000, v222
    v_fmac_f32 v16, v32, v40
    v_fmac_f32 v24, v32, v41
    v_fmac_f32 v17, v33, v40
    v_fmac_f32 v25, v33, v41
    v_fmac_f32 v18, v34, v40
    v_fmac_f32 v26, v34, v41
    v_fmac_f32 v19, v35, v40
    v_fmac_f32 v27, v35, v41
    v_fmac_f32 v20, v36, v40
    v_fmac_f32 v28, v36, v41
    v_fmac_f32 v21, v37, v40
    v_fmac_f32 v29, v37, v41
    v_fmac_f32 v22, v38, v40
    v_fmac_f32 v30, v38, v41
    v_fmac_f32 v23, v39, v40
    v_fmac_f32 v31, v39, v41
    s_waitcnt vmcnt(9)
    v_lshlrev_b32 v32, 16, v184
    v_and_b32 v33, 0xffff0000, v184
    v_lshlrev_b32 v34, 16, v185
    v_and_b32 v35, 0xffff0000, v185
    v_lshlrev_b32 v36, 16, v186
    v_and_b32 v37, 0xffff0000, v186
    v_lshlrev_b32 v38, 16, v187
    v_and_b32 v39, 0xffff0000, v187
    v_lshlrev_b32 v40, 16, v207
    v_lshlrev_b32 v41, 16, v223
    v_fmac_f32 v16, v32, v40
    v_fmac_f32 v24, v32, v41
    v_fmac_f32 v17, v33, v40
    v_fmac_f32 v25, v33, v41
    v_fmac_f32 v18, v34, v40
    v_fmac_f32 v26, v34, v41
    v_fmac_f32 v19, v35, v40
    v_fmac_f32 v27, v35, v41
    v_fmac_f32 v20, v36, v40
    v_fmac_f32 v28, v36, v41
    v_fmac_f32 v21, v37, v40
    v_fmac_f32 v29, v37, v41
    v_fmac_f32 v22, v38, v40
    v_fmac_f32 v30, v38, v41
    v_fmac_f32 v23, v39, v40
    v_fmac_f32 v31, v39, v41
    s_waitcnt vmcnt(8)
    v_lshlrev_b32 v32, 16, v188
    v_and_b32 v33, 0xffff0000, v188
    v_lshlrev_b32 v34, 16, v189
    v_and_b32 v35, 0xffff0000, v189
    v_lshlrev_b32 v36, 16, v190
    v_and_b32 v37, 0xffff0000, v190
    v_lshlrev_b32 v38, 16, v191
    v_and_b32 v39, 0xffff0000, v191
    v_and_b32 v40, 0xffff0000, v207
    v_and_b32 v41, 0xffff0000, v223
    v_fmac_f32 v16, v32, v40
    v_fmac_f32 v24, v32, v41
    v_fmac_f32 v17, v33, v40
    v_fmac_f32 v25, v33, v41
    v_fmac_f32 v18, v34, v40
    v_fmac_f32 v26, v34, v41
    v_fmac_f32 v19, v35, v40
    v_fmac_f32 v27, v35, v41
    v_fmac_f32 v20, v36, v40
    v_fmac_f32 v28, v36, v41
    v_fmac_f32 v21, v37, v40
    v_fmac_f32 v29, v37, v41
    v_fmac_f32 v22, v38, v40
    v_fmac_f32 v30, v38, v41
    v_fmac_f32 v23, v39, v40
    v_fmac_f32 v31, v39, v41
    v_lshlrev_b32 v12, 10, v1
    v_lshlrev_b32 v13, 5, v2
    v_add_u32 v12, v12, v13
    ds_write_b128 v12, v[16:19]
    ds_write_b128 v12, v[20:23] offset:16
    ds_write_b128 v12, v[24:27] offset:512
    ds_write_b128 v12, v[28:31] offset:528
    s_waitcnt lgkmcnt(0)
    s_barrier
    v_lshlrev_b32 v12, 2, v0
    ds_read_b32 v32, v12 offset:0
    ds_read_b32 v33, v12 offset:1024
    ds_read_b32 v34, v12 offset:2048
    ds_read_b32 v35, v12 offset:3072
    ds_read_b32 v36, v12 offset:4096
    ds_read_b32 v37, v12 offset:5120
    ds_read_b32 v38, v12 offset:6144
    ds_read_b32 v39, v12 offset:7168
    ds_read_b32 v40, v12 offset:8192
    ds_read_b32 v41, v12 offset:9216
    ds_read_b32 v42, v12 offset:10240
    ds_read_b32 v43, v12 offset:11264
    ds_read_b32 v44, v12 offset:12288
    ds_read_b32 v45, v12 offset:13312
    ds_read_b32 v46, v12 offset:14336
    ds_read_b32 v47, v12 offset:15360
    s_waitcnt lgkmcnt(0)
    v_add_f32 v32, v32, v33
    v_add_f32 v32, v32, v34
    v_add_f32 v32, v32, v35
    v_add_f32 v32, v32, v36
    v_add_f32 v32, v32, v37
    v_add_f32 v32, v32, v38
    v_add_f32 v32, v32, v39
    v_add_f32 v32, v32, v40
    v_add_f32 v32, v32, v41
    v_add_f32 v32, v32, v42
    v_add_f32 v32, v32, v43
    v_add_f32 v32, v32, v44
    v_add_f32 v32, v32, v45
    v_add_f32 v32, v32, v46
    v_add_f32 v32, v32, v47
    v_cvt_pk_bf16_f32 v33, v32, v32
    v_lshlrev_b32 v13, 1, v0
    ds_write_b16 v13, v33 offset:16384
    v_mov_b32 v64, 0
    v_mov_b32 v65, 0
    v_mov_b32 v66, 0
    v_mov_b32 v67, 0
    v_mov_b32 v68, 0
    v_mov_b32 v69, 0
    v_mov_b32 v70, 0
    v_mov_b32 v71, 0
    v_mov_b32 v72, 0
    v_mov_b32 v73, 0
    v_mov_b32 v74, 0
    v_mov_b32 v75, 0
    v_mov_b32 v76, 0
    v_mov_b32 v77, 0
    v_mov_b32 v78, 0
    v_mov_b32 v79, 0
    s_waitcnt lgkmcnt(0)
    s_barrier
    v_cmp_gt_u32 vcc, 2, v8
    v_lshlrev_b32 v12, 8, v8
    v_lshlrev_b32 v13, 4, v9
    v_add_u32 v12, v12, v13
    s_nop 1
    s_and_saveexec_b64 s[16:17], vcc
    ds_read_b128 v[64:67], v12 offset:16384
    ds_read_b128 v[68:71], v12 offset:16448
    ds_read_b128 v[72:75], v12 offset:16512
    ds_read_b128 v[76:79], v12 offset:16576
    s_mov_b64 exec, s[16:17]
    s_waitcnt vmcnt(0) lgkmcnt(0)
    v_mfma_f32_16x16x32_bf16 v[96:99], v[224:227], v[64:67], 0
    v_mfma_f32_16x16x32_bf16 v[96:99], v[228:231], v[68:71], v[96:99]
    v_mfma_f32_16x16x32_bf16 v[96:99], v[232:235], v[72:75], v[96:99]
    v_mfma_f32_16x16x32_bf16 v[96:99], v[236:239], v[76:79], v[96:99]
    v_mfma_f32_16x16x32_bf16 v[100:103], v[240:243], v[64:67], 0
    v_mfma_f32_16x16x32_bf16 v[100:103], v[244:247], v[68:71], v[100:103]
    v_mfma_f32_16x16x32_bf16 v[100:103], v[248:251], v[72:75], v[100:103]
    v_mfma_f32_16x16x32_bf16 v[100:103], v[252:255], v[76:79], v[100:103]
    s_nop 7
    s_nop 7
    v_cvt_pk_bf16_f32 v104, v96, v97
    v_cvt_pk_bf16_f32 v105, v98, v99
    v_cvt_pk_bf16_f32 v106, v100, v101
    v_cvt_pk_bf16_f32 v107, v102, v103
    v_lshlrev_b32 v12, 15, v8
    v_lshlrev_b32 v13, 6, v7
    v_lshlrev_b32 v14, 3, v9
    v_add3_u32 v12, v12, v13, v14
    s_lshl_b32 s18, s12, 10
    s_lshl_b32 s19, s13, 8
    s_add_u32 s18, s18, s19
    s_add_u32 s18, s18, 0x10000
    v_add_u32 v12, s18, v12
    s_and_saveexec_b64 s[16:17], vcc
    global_store_dwordx2 v12, v[104:105], s[4:5]
    global_store_dwordx2 v12, v[106:107], s[4:5] offset:32
    s_mov_b64 exec, s[16:17]
    s_branch K1_END
K1_A:
    s_load_dwordx2 s[6:7], s[0:1], 0
    s_load_dwordx2 s[8:9], s[0:1], 24
    s_sub_u32 s12, s2, 128
    s_lshl_b32 s14, s12, 7
    v_lshrrev_b32 v1, 3, v0
    v_and_b32 v2, 7, v0
    v_lshlrev_b32 v3, 17, v1
    v_lshlrev_b32 v4, 4, v2
    v_add3_u32 v3, v3, v4, s14
    v_lshlrev_b32 v5, 5, v1
    s_waitcnt lgkmcnt(0)
    global_load_dwordx4 v[160:163], v5, s[6:7] offset:0
    global_load_dwordx4 v[164:167], v5, s[6:7] offset:16
    global_load_dwordx4 v[168:171], v5, s[6:7] offset:1024
    global_load_dwordx4 v[172:175], v5, s[6:7] offset:1040
    global_load_dwordx4 v[64:67], v3, s[8:9]
    v_add_u32 v3, 0x2000, v3
    global_load_dwordx4 v[68:71], v3, s[8:9]
    v_add_u32 v3, 0x2000, v3
    global_load_dwordx4 v[72:75], v3, s[8:9]
    v_add_u32 v3, 0x2000, v3
    global_load_dwordx4 v[76:79], v3, s[8:9]
    v_add_u32 v3, 0x2000, v3
    global_load_dwordx4 v[80:83], v3, s[8:9]
    v_add_u32 v3, 0x2000, v3
    global_load_dwordx4 v[84:87], v3, s[8:9]
    v_add_u32 v3, 0x2000, v3
    global_load_dwordx4 v[88:91], v3, s[8:9]
    v_add_u32 v3, 0x2000, v3
    global_load_dwordx4 v[92:95], v3, s[8:9]
    v_add_u32 v3, 0x2000, v3
    global_load_dwordx4 v[96:99], v3, s[8:9]
    v_add_u32 v3, 0x2000, v3
    global_load_dwordx4 v[100:103], v3, s[8:9]
    v_add_u32 v3, 0x2000, v3
    global_load_dwordx4 v[104:107], v3, s[8:9]
    v_add_u32 v3, 0x2000, v3
    global_load_dwordx4 v[108:111], v3, s[8:9]
    v_add_u32 v3, 0x2000, v3
    global_load_dwordx4 v[112:115], v3, s[8:9]
    v_add_u32 v3, 0x2000, v3
    global_load_dwordx4 v[116:119], v3, s[8:9]
    v_add_u32 v3, 0x2000, v3
    global_load_dwordx4 v[120:123], v3, s[8:9]
    v_add_u32 v3, 0x2000, v3
    global_load_dwordx4 v[124:127], v3, s[8:9]
    v_add_u32 v3, 0x2000, v3
    v_mov_b32 v16, 0
    v_mov_b32 v17, 0
    v_mov_b32 v18, 0
    v_mov_b32 v19, 0
    v_mov_b32 v20, 0
    v_mov_b32 v21, 0
    v_mov_b32 v22, 0
    v_mov_b32 v23, 0
    v_mov_b32 v24, 0
    v_mov_b32 v25, 0
    v_mov_b32 v26, 0
    v_mov_b32 v27, 0
    v_mov_b32 v28, 0
    v_mov_b32 v29, 0
    v_mov_b32 v30, 0
    v_mov_b32 v31, 0
    s_waitcnt vmcnt(15)
    v_lshlrev_b32 v32, 16, v64
    v_and_b32 v33, 0xffff0000, v64
    v_lshlrev_b32 v34, 16, v65
    v_and_b32 v35, 0xffff0000, v65
    v_lshlrev_b32 v36, 16, v66
    v_and_b32 v37, 0xffff0000, v66
    v_lshlrev_b32 v38, 16, v67
    v_and_b32 v39, 0xffff0000, v67
    v_lshlrev_b32 v40, 16, v160
    v_lshlrev_b32 v41, 16, v168
    v_fmac_f32 v16, v32, v40
    v_fmac_f32 v24, v32, v41
    v_fmac_f32 v17, v33, v40
    v_fmac_f32 v25, v33, v41
    v_fmac_f32 v18, v34, v40
    v_fmac_f32 v26, v34, v41
    v_fmac_f32 v19, v35, v40
    v_fmac_f32 v27, v35, v41
    v_fmac_f32 v20, v36, v40
    v_fmac_f32 v28, v36, v41
    v_fmac_f32 v21, v37, v40
    v_fmac_f32 v29, v37, v41
    v_fmac_f32 v22, v38, v40
    v_fmac_f32 v30, v38, v41
    v_fmac_f32 v23, v39, v40
    v_fmac_f32 v31, v39, v41
    s_waitcnt vmcnt(14)
    v_lshlrev_b32 v32, 16, v68
    v_and_b32 v33, 0xffff0000, v68
    v_lshlrev_b32 v34, 16, v69
    v_and_b32 v35, 0xffff0000, v69
    v_lshlrev_b32 v36, 16, v70
    v_and_b32 v37, 0xffff0000, v70
    v_lshlrev_b32 v38, 16, v71
    v_and_b32 v39, 0xffff0000, v71
    v_and_b32 v40, 0xffff0000, v160
    v_and_b32 v41, 0xffff0000, v168
    v_fmac_f32 v16, v32, v40
    v_fmac_f32 v24, v32, v41
    v_fmac_f32 v17, v33, v40
    v_fmac_f32 v25, v33, v41
    v_fmac_f32 v18, v34, v40
    v_fmac_f32 v26, v34, v41
    v_fmac_f32 v19, v35, v40
    v_fmac_f32 v27, v35, v41
    v_fmac_f32 v20, v36, v40
    v_fmac_f32 v28, v36, v41
    v_fmac_f32 v21, v37, v40
    v_fmac_f32 v29, v37, v41
    v_fmac_f32 v22, v38, v40
    v_fmac_f32 v30, v38, v41
    v_fmac_f32 v23, v39, v40
    v_fmac_f32 v31, v39, v41
    s_waitcnt vmcnt(13)
    v_lshlrev_b32 v32, 16, v72
    v_and_b32 v33, 0xffff0000, v72
    v_lshlrev_b32 v34, 16, v73
    v_and_b32 v35, 0xffff0000, v73
    v_lshlrev_b32 v36, 16, v74
    v_and_b32 v37, 0xffff0000, v74
    v_lshlrev_b32 v38, 16, v75
    v_and_b32 v39, 0xffff0000, v75
    v_lshlrev_b32 v40, 16, v161
    v_lshlrev_b32 v41, 16, v169
    v_fmac_f32 v16, v32, v40
    v_fmac_f32 v24, v32, v41
    v_fmac_f32 v17, v33, v40
    v_fmac_f32 v25, v33, v41
    v_fmac_f32 v18, v34, v40
    v_fmac_f32 v26, v34, v41
    v_fmac_f32 v19, v35, v40
    v_fmac_f32 v27, v35, v41
    v_fmac_f32 v20, v36, v40
    v_fmac_f32 v28, v36, v41
    v_fmac_f32 v21, v37, v40
    v_fmac_f32 v29, v37, v41
    v_fmac_f32 v22, v38, v40
    v_fmac_f32 v30, v38, v41
    v_fmac_f32 v23, v39, v40
    v_fmac_f32 v31, v39, v41
    s_waitcnt vmcnt(12)
    v_lshlrev_b32 v32, 16, v76
    v_and_b32 v33, 0xffff0000, v76
    v_lshlrev_b32 v34, 16, v77
    v_and_b32 v35, 0xffff0000, v77
    v_lshlrev_b32 v36, 16, v78
    v_and_b32 v37, 0xffff0000, v78
    v_lshlrev_b32 v38, 16, v79
    v_and_b32 v39, 0xffff0000, v79
    v_and_b32 v40, 0xffff0000, v161
    v_and_b32 v41, 0xffff0000, v169
    v_fmac_f32 v16, v32, v40
    v_fmac_f32 v24, v32, v41
    v_fmac_f32 v17, v33, v40
    v_fmac_f32 v25, v33, v41
    v_fmac_f32 v18, v34, v40
    v_fmac_f32 v26, v34, v41
    v_fmac_f32 v19, v35, v40
    v_fmac_f32 v27, v35, v41
    v_fmac_f32 v20, v36, v40
    v_fmac_f32 v28, v36, v41
    v_fmac_f32 v21, v37, v40
    v_fmac_f32 v29, v37, v41
    v_fmac_f32 v22, v38, v40
    v_fmac_f32 v30, v38, v41
    v_fmac_f32 v23, v39, v40
    v_fmac_f32 v31, v39, v41
    s_waitcnt vmcnt(11)
    v_lshlrev_b32 v32, 16, v80
    v_and_b32 v33, 0xffff0000, v80
    v_lshlrev_b32 v34, 16, v81
    v_and_b32 v35, 0xffff0000, v81
    v_lshlrev_b32 v36, 16, v82
    v_and_b32 v37, 0xffff0000, v82
    v_lshlrev_b32 v38, 16, v83
    v_and_b32 v39, 0xffff0000, v83
    v_lshlrev_b32 v40, 16, v162
    v_lshlrev_b32 v41, 16, v170
    v_fmac_f32 v16, v32, v40
    v_fmac_f32 v24, v32, v41
    v_fmac_f32 v17, v33, v40
    v_fmac_f32 v25, v33, v41
    v_fmac_f32 v18, v34, v40
    v_fmac_f32 v26, v34, v41
    v_fmac_f32 v19, v35, v40
    v_fmac_f32 v27, v35, v41
    v_fmac_f32 v20, v36, v40
    v_fmac_f32 v28, v36, v41
    v_fmac_f32 v21, v37, v40
    v_fmac_f32 v29, v37, v41
    v_fmac_f32 v22, v38, v40
    v_fmac_f32 v30, v38, v41
    v_fmac_f32 v23, v39, v40
    v_fmac_f32 v31, v39, v41
    s_waitcnt vmcnt(10)
    v_lshlrev_b32 v32, 16, v84
    v_and_b32 v33, 0xffff0000, v84
    v_lshlrev_b32 v34, 16, v85
    v_and_b32 v35, 0xffff0000, v85
    v_lshlrev_b32 v36, 16, v86
    v_and_b32 v37, 0xffff0000, v86
    v_lshlrev_b32 v38, 16, v87
    v_and_b32 v39, 0xffff0000, v87
    v_and_b32 v40, 0xffff0000, v162
    v_and_b32 v41, 0xffff0000, v170
    v_fmac_f32 v16, v32, v40
    v_fmac_f32 v24, v32, v41
    v_fmac_f32 v17, v33, v40
    v_fmac_f32 v25, v33, v41
    v_fmac_f32 v18, v34, v40
    v_fmac_f32 v26, v34, v41
    v_fmac_f32 v19, v35, v40
    v_fmac_f32 v27, v35, v41
    v_fmac_f32 v20, v36, v40
    v_fmac_f32 v28, v36, v41
    v_fmac_f32 v21, v37, v40
    v_fmac_f32 v29, v37, v41
    v_fmac_f32 v22, v38, v40
    v_fmac_f32 v30, v38, v41
    v_fmac_f32 v23, v39, v40
    v_fmac_f32 v31, v39, v41
    s_waitcnt vmcnt(9)
    v_lshlrev_b32 v32, 16, v88
    v_and_b32 v33, 0xffff0000, v88
    v_lshlrev_b32 v34, 16, v89
    v_and_b32 v35, 0xffff0000, v89
    v_lshlrev_b32 v36, 16, v90
    v_and_b32 v37, 0xffff0000, v90
    v_lshlrev_b32 v38, 16, v91
    v_and_b32 v39, 0xffff0000, v91
    v_lshlrev_b32 v40, 16, v163
    v_lshlrev_b32 v41, 16, v171
    v_fmac_f32 v16, v32, v40
    v_fmac_f32 v24, v32, v41
    v_fmac_f32 v17, v33, v40
    v_fmac_f32 v25, v33, v41
    v_fmac_f32 v18, v34, v40
    v_fmac_f32 v26, v34, v41
    v_fmac_f32 v19, v35, v40
    v_fmac_f32 v27, v35, v41
    v_fmac_f32 v20, v36, v40
    v_fmac_f32 v28, v36, v41
    v_fmac_f32 v21, v37, v40
    v_fmac_f32 v29, v37, v41
    v_fmac_f32 v22, v38, v40
    v_fmac_f32 v30, v38, v41
    v_fmac_f32 v23, v39, v40
    v_fmac_f32 v31, v39, v41
    s_waitcnt vmcnt(8)
    v_lshlrev_b32 v32, 16, v92
    v_and_b32 v33, 0xffff0000, v92
    v_lshlrev_b32 v34, 16, v93
    v_and_b32 v35, 0xffff0000, v93
    v_lshlrev_b32 v36, 16, v94
    v_and_b32 v37, 0xffff0000, v94
    v_lshlrev_b32 v38, 16, v95
    v_and_b32 v39, 0xffff0000, v95
    v_and_b32 v40, 0xffff0000, v163
    v_and_b32 v41, 0xffff0000, v171
    v_fmac_f32 v16, v32, v40
    v_fmac_f32 v24, v32, v41
    v_fmac_f32 v17, v33, v40
    v_fmac_f32 v25, v33, v41
    v_fmac_f32 v18, v34, v40
    v_fmac_f32 v26, v34, v41
    v_fmac_f32 v19, v35, v40
    v_fmac_f32 v27, v35, v41
    v_fmac_f32 v20, v36, v40
    v_fmac_f32 v28, v36, v41
    v_fmac_f32 v21, v37, v40
    v_fmac_f32 v29, v37, v41
    v_fmac_f32 v22, v38, v40
    v_fmac_f32 v30, v38, v41
    v_fmac_f32 v23, v39, v40
    v_fmac_f32 v31, v39, v41
    s_waitcnt vmcnt(7)
    v_lshlrev_b32 v32, 16, v96
    v_and_b32 v33, 0xffff0000, v96
    v_lshlrev_b32 v34, 16, v97
    v_and_b32 v35, 0xffff0000, v97
    v_lshlrev_b32 v36, 16, v98
    v_and_b32 v37, 0xffff0000, v98
    v_lshlrev_b32 v38, 16, v99
    v_and_b32 v39, 0xffff0000, v99
    v_lshlrev_b32 v40, 16, v164
    v_lshlrev_b32 v41, 16, v172
    v_fmac_f32 v16, v32, v40
    v_fmac_f32 v24, v32, v41
    v_fmac_f32 v17, v33, v40
    v_fmac_f32 v25, v33, v41
    v_fmac_f32 v18, v34, v40
    v_fmac_f32 v26, v34, v41
    v_fmac_f32 v19, v35, v40
    v_fmac_f32 v27, v35, v41
    v_fmac_f32 v20, v36, v40
    v_fmac_f32 v28, v36, v41
    v_fmac_f32 v21, v37, v40
    v_fmac_f32 v29, v37, v41
    v_fmac_f32 v22, v38, v40
    v_fmac_f32 v30, v38, v41
    v_fmac_f32 v23, v39, v40
    v_fmac_f32 v31, v39, v41
    s_waitcnt vmcnt(6)
    v_lshlrev_b32 v32, 16, v100
    v_and_b32 v33, 0xffff0000, v100
    v_lshlrev_b32 v34, 16, v101
    v_and_b32 v35, 0xffff0000, v101
    v_lshlrev_b32 v36, 16, v102
    v_and_b32 v37, 0xffff0000, v102
    v_lshlrev_b32 v38, 16, v103
    v_and_b32 v39, 0xffff0000, v103
    v_and_b32 v40, 0xffff0000, v164
    v_and_b32 v41, 0xffff0000, v172
    v_fmac_f32 v16, v32, v40
    v_fmac_f32 v24, v32, v41
    v_fmac_f32 v17, v33, v40
    v_fmac_f32 v25, v33, v41
    v_fmac_f32 v18, v34, v40
    v_fmac_f32 v26, v34, v41
    v_fmac_f32 v19, v35, v40
    v_fmac_f32 v27, v35, v41
    v_fmac_f32 v20, v36, v40
    v_fmac_f32 v28, v36, v41
    v_fmac_f32 v21, v37, v40
    v_fmac_f32 v29, v37, v41
    v_fmac_f32 v22, v38, v40
    v_fmac_f32 v30, v38, v41
    v_fmac_f32 v23, v39, v40
    v_fmac_f32 v31, v39, v41
    s_waitcnt vmcnt(5)
    v_lshlrev_b32 v32, 16, v104
    v_and_b32 v33, 0xffff0000, v104
    v_lshlrev_b32 v34, 16, v105
    v_and_b32 v35, 0xffff0000, v105
    v_lshlrev_b32 v36, 16, v106
    v_and_b32 v37, 0xffff0000, v106
    v_lshlrev_b32 v38, 16, v107
    v_and_b32 v39, 0xffff0000, v107
    v_lshlrev_b32 v40, 16, v165
    v_lshlrev_b32 v41, 16, v173
    v_fmac_f32 v16, v32, v40
    v_fmac_f32 v24, v32, v41
    v_fmac_f32 v17, v33, v40
    v_fmac_f32 v25, v33, v41
    v_fmac_f32 v18, v34, v40
    v_fmac_f32 v26, v34, v41
    v_fmac_f32 v19, v35, v40
    v_fmac_f32 v27, v35, v41
    v_fmac_f32 v20, v36, v40
    v_fmac_f32 v28, v36, v41
    v_fmac_f32 v21, v37, v40
    v_fmac_f32 v29, v37, v41
    v_fmac_f32 v22, v38, v40
    v_fmac_f32 v30, v38, v41
    v_fmac_f32 v23, v39, v40
    v_fmac_f32 v31, v39, v41
    s_waitcnt vmcnt(4)
    v_lshlrev_b32 v32, 16, v108
    v_and_b32 v33, 0xffff0000, v108
    v_lshlrev_b32 v34, 16, v109
    v_and_b32 v35, 0xffff0000, v109
    v_lshlrev_b32 v36, 16, v110
    v_and_b32 v37, 0xffff0000, v110
    v_lshlrev_b32 v38, 16, v111
    v_and_b32 v39, 0xffff0000, v111
    v_and_b32 v40, 0xffff0000, v165
    v_and_b32 v41, 0xffff0000, v173
    v_fmac_f32 v16, v32, v40
    v_fmac_f32 v24, v32, v41
    v_fmac_f32 v17, v33, v40
    v_fmac_f32 v25, v33, v41
    v_fmac_f32 v18, v34, v40
    v_fmac_f32 v26, v34, v41
    v_fmac_f32 v19, v35, v40
    v_fmac_f32 v27, v35, v41
    v_fmac_f32 v20, v36, v40
    v_fmac_f32 v28, v36, v41
    v_fmac_f32 v21, v37, v40
    v_fmac_f32 v29, v37, v41
    v_fmac_f32 v22, v38, v40
    v_fmac_f32 v30, v38, v41
    v_fmac_f32 v23, v39, v40
    v_fmac_f32 v31, v39, v41
    s_waitcnt vmcnt(3)
    v_lshlrev_b32 v32, 16, v112
    v_and_b32 v33, 0xffff0000, v112
    v_lshlrev_b32 v34, 16, v113
    v_and_b32 v35, 0xffff0000, v113
    v_lshlrev_b32 v36, 16, v114
    v_and_b32 v37, 0xffff0000, v114
    v_lshlrev_b32 v38, 16, v115
    v_and_b32 v39, 0xffff0000, v115
    v_lshlrev_b32 v40, 16, v166
    v_lshlrev_b32 v41, 16, v174
    v_fmac_f32 v16, v32, v40
    v_fmac_f32 v24, v32, v41
    v_fmac_f32 v17, v33, v40
    v_fmac_f32 v25, v33, v41
    v_fmac_f32 v18, v34, v40
    v_fmac_f32 v26, v34, v41
    v_fmac_f32 v19, v35, v40
    v_fmac_f32 v27, v35, v41
    v_fmac_f32 v20, v36, v40
    v_fmac_f32 v28, v36, v41
    v_fmac_f32 v21, v37, v40
    v_fmac_f32 v29, v37, v41
    v_fmac_f32 v22, v38, v40
    v_fmac_f32 v30, v38, v41
    v_fmac_f32 v23, v39, v40
    v_fmac_f32 v31, v39, v41
    s_waitcnt vmcnt(2)
    v_lshlrev_b32 v32, 16, v116
    v_and_b32 v33, 0xffff0000, v116
    v_lshlrev_b32 v34, 16, v117
    v_and_b32 v35, 0xffff0000, v117
    v_lshlrev_b32 v36, 16, v118
    v_and_b32 v37, 0xffff0000, v118
    v_lshlrev_b32 v38, 16, v119
    v_and_b32 v39, 0xffff0000, v119
    v_and_b32 v40, 0xffff0000, v166
    v_and_b32 v41, 0xffff0000, v174
    v_fmac_f32 v16, v32, v40
    v_fmac_f32 v24, v32, v41
    v_fmac_f32 v17, v33, v40
    v_fmac_f32 v25, v33, v41
    v_fmac_f32 v18, v34, v40
    v_fmac_f32 v26, v34, v41
    v_fmac_f32 v19, v35, v40
    v_fmac_f32 v27, v35, v41
    v_fmac_f32 v20, v36, v40
    v_fmac_f32 v28, v36, v41
    v_fmac_f32 v21, v37, v40
    v_fmac_f32 v29, v37, v41
    v_fmac_f32 v22, v38, v40
    v_fmac_f32 v30, v38, v41
    v_fmac_f32 v23, v39, v40
    v_fmac_f32 v31, v39, v41
    s_waitcnt vmcnt(1)
    v_lshlrev_b32 v32, 16, v120
    v_and_b32 v33, 0xffff0000, v120
    v_lshlrev_b32 v34, 16, v121
    v_and_b32 v35, 0xffff0000, v121
    v_lshlrev_b32 v36, 16, v122
    v_and_b32 v37, 0xffff0000, v122
    v_lshlrev_b32 v38, 16, v123
    v_and_b32 v39, 0xffff0000, v123
    v_lshlrev_b32 v40, 16, v167
    v_lshlrev_b32 v41, 16, v175
    v_fmac_f32 v16, v32, v40
    v_fmac_f32 v24, v32, v41
    v_fmac_f32 v17, v33, v40
    v_fmac_f32 v25, v33, v41
    v_fmac_f32 v18, v34, v40
    v_fmac_f32 v26, v34, v41
    v_fmac_f32 v19, v35, v40
    v_fmac_f32 v27, v35, v41
    v_fmac_f32 v20, v36, v40
    v_fmac_f32 v28, v36, v41
    v_fmac_f32 v21, v37, v40
    v_fmac_f32 v29, v37, v41
    v_fmac_f32 v22, v38, v40
    v_fmac_f32 v30, v38, v41
    v_fmac_f32 v23, v39, v40
    v_fmac_f32 v31, v39, v41
    s_waitcnt vmcnt(0)
    v_lshlrev_b32 v32, 16, v124
    v_and_b32 v33, 0xffff0000, v124
    v_lshlrev_b32 v34, 16, v125
    v_and_b32 v35, 0xffff0000, v125
    v_lshlrev_b32 v36, 16, v126
    v_and_b32 v37, 0xffff0000, v126
    v_lshlrev_b32 v38, 16, v127
    v_and_b32 v39, 0xffff0000, v127
    v_and_b32 v40, 0xffff0000, v167
    v_and_b32 v41, 0xffff0000, v175
    v_fmac_f32 v16, v32, v40
    v_fmac_f32 v24, v32, v41
    v_fmac_f32 v17, v33, v40
    v_fmac_f32 v25, v33, v41
    v_fmac_f32 v18, v34, v40
    v_fmac_f32 v26, v34, v41
    v_fmac_f32 v19, v35, v40
    v_fmac_f32 v27, v35, v41
    v_fmac_f32 v20, v36, v40
    v_fmac_f32 v28, v36, v41
    v_fmac_f32 v21, v37, v40
    v_fmac_f32 v29, v37, v41
    v_fmac_f32 v22, v38, v40
    v_fmac_f32 v30, v38, v41
    v_fmac_f32 v23, v39, v40
    v_fmac_f32 v31, v39, v41
    v_lshlrev_b32 v12, 9, v1
    v_lshlrev_b32 v13, 5, v2
    v_add_u32 v12, v12, v13
    ds_write_b128 v12, v[16:19]
    ds_write_b128 v12, v[20:23] offset:16
    ds_write_b128 v12, v[24:27] offset:256
    ds_write_b128 v12, v[28:31] offset:272
    s_waitcnt lgkmcnt(0)
    s_barrier
    v_cmp_gt_u32 vcc, 128, v0
    v_lshlrev_b32 v12, 2, v0
    s_nop 1
    s_and_saveexec_b64 s[16:17], vcc
    s_cbranch_execz K1_A_SKIP
    ds_read_b32 v64, v12 offset:0
    ds_read_b32 v65, v12 offset:512
    ds_read_b32 v66, v12 offset:1024
    ds_read_b32 v67, v12 offset:1536
    ds_read_b32 v68, v12 offset:2048
    ds_read_b32 v69, v12 offset:2560
    ds_read_b32 v70, v12 offset:3072
    ds_read_b32 v71, v12 offset:3584
    ds_read_b32 v72, v12 offset:4096
    ds_read_b32 v73, v12 offset:4608
    ds_read_b32 v74, v12 offset:5120
    ds_read_b32 v75, v12 offset:5632
    ds_read_b32 v76, v12 offset:6144
    ds_read_b32 v77, v12 offset:6656
    ds_read_b32 v78, v12 offset:7168
    ds_read_b32 v79, v12 offset:7680
    ds_read_b32 v80, v12 offset:8192
    ds_read_b32 v81, v12 offset:8704
    ds_read_b32 v82, v12 offset:9216
    ds_read_b32 v83, v12 offset:9728
    ds_read_b32 v84, v12 offset:10240
    ds_read_b32 v85, v12 offset:10752
    ds_read_b32 v86, v12 offset:11264
    ds_read_b32 v87, v12 offset:11776
    ds_read_b32 v88, v12 offset:12288
    ds_read_b32 v89, v12 offset:12800
    ds_read_b32 v90, v12 offset:13312
    ds_read_b32 v91, v12 offset:13824
    ds_read_b32 v92, v12 offset:14336
    ds_read_b32 v93, v12 offset:14848
    ds_read_b32 v94, v12 offset:15360
    ds_read_b32 v95, v12 offset:15872
    s_waitcnt lgkmcnt(0)
    v_add_f32 v64, v64, v65
    v_add_f32 v64, v64, v66
    v_add_f32 v64, v64, v67
    v_add_f32 v64, v64, v68
    v_add_f32 v64, v64, v69
    v_add_f32 v64, v64, v70
    v_add_f32 v64, v64, v71
    v_add_f32 v64, v64, v72
    v_add_f32 v64, v64, v73
    v_add_f32 v64, v64, v74
    v_add_f32 v64, v64, v75
    v_add_f32 v64, v64, v76
    v_add_f32 v64, v64, v77
    v_add_f32 v64, v64, v78
    v_add_f32 v64, v64, v79
    v_add_f32 v64, v64, v80
    v_add_f32 v64, v64, v81
    v_add_f32 v64, v64, v82
    v_add_f32 v64, v64, v83
    v_add_f32 v64, v64, v84
    v_add_f32 v64, v64, v85
    v_add_f32 v64, v64, v86
    v_add_f32 v64, v64, v87
    v_add_f32 v64, v64, v88
    v_add_f32 v64, v64, v89
    v_add_f32 v64, v64, v90
    v_add_f32 v64, v64, v91
    v_add_f32 v64, v64, v92
    v_add_f32 v64, v64, v93
    v_add_f32 v64, v64, v94
    v_add_f32 v64, v64, v95
    v_cvt_pk_bf16_f32 v65, v64, v64
    v_lshrrev_b32 v13, 6, v0
    v_lshlrev_b32 v13, 13, v13
    v_and_b32 v14, 63, v0
    v_lshlrev_b32 v14, 1, v14
    v_add3_u32 v13, v13, v14, s14
    global_store_short v13, v65, s[4:5] offset:0
K1_A_SKIP:
    s_mov_b64 exec, s[16:17]
K1_END:
K1_EXIT:
    s_endpgm
.globl k2att_kernel
.p2align 8
.type k2att_kernel,@function
k2att_kernel:
    s_cmp_ge_u32 s2, 256
    s_cbranch_scc1 K2_EXIT
    s_load_dwordx2 s[4:5], s[0:1], 104
    s_mov_b32 s20, 0x3db504f3
    s_mov_b32 s21, 0x3fb8aa3b
    v_and_b32 v6, 63, v0
    v_lshrrev_b32 v7, 6, v0
    s_nop 0
    v_readfirstlane_b32 s22, v7
    v_and_b32 v8, 15, v6
    v_lshrrev_b32 v9, 4, v6
    s_cmp_ge_u32 s2, 128
    s_cbranch_scc1 K2_APRE
    s_load_dwordx2 s[6:7], s[0:1], 48
    s_lshr_b32 s23, s2, 6
    s_and_b32 s24, s2, 63
    s_waitcnt lgkmcnt(0)
    s_lshl_b32 s25, s2, 17
    s_lshl_b32 s26, s22, 8
    s_add_u32 s25, s25, s26
    s_add_u32 s6, s6, s25
    s_addc_u32 s7, s7, 0
    s_lshl_b32 s25, s23, 15
    s_lshl_b32 s26, s22, 8
    s_add_u32 s25, s25, s26
    s_add_u32 s25, s25, 0x10000
    v_lshlrev_b32 v10, 10, v8
    v_lshlrev_b32 v11, 4, v9
    v_add_u32 v10, v10, v11
    v_add_u32 v11, s25, v10
    v_add_u32 v12, 0x4000, v11
    global_load_dwordx4 v[192:195], v11, s[4:5] offset:0
    global_load_dwordx4 v[196:199], v11, s[4:5] offset:64
    global_load_dwordx4 v[200:203], v11, s[4:5] offset:128
    global_load_dwordx4 v[204:207], v11, s[4:5] offset:192
    global_load_dwordx4 v[208:211], v12, s[4:5] offset:0
    global_load_dwordx4 v[212:215], v12, s[4:5] offset:64
    global_load_dwordx4 v[216:219], v12, s[4:5] offset:128
    global_load_dwordx4 v[220:223], v12, s[4:5] offset:192
    v_mov_b32 v13, v10
    global_load_dwordx4 a[0:3], v13, s[6:7] offset:0
    global_load_dwordx4 a[4:7], v13, s[6:7] offset:64
    global_load_dwordx4 a[8:11], v13, s[6:7] offset:128
    global_load_dwordx4 a[12:15], v13, s[6:7] offset:192
    v_add_u32 v13, 0x4000, v13
    global_load_dwordx4 a[16:19], v13, s[6:7] offset:0
    global_load_dwordx4 a[20:23], v13, s[6:7] offset:64
    global_load_dwordx4 a[24:27], v13, s[6:7] offset:128
    global_load_dwordx4 a[28:31], v13, s[6:7] offset:192
    v_add_u32 v13, 0x4000, v13
    global_load_dwordx4 a[32:35], v13, s[6:7] offset:0
    global_load_dwordx4 a[36:39], v13, s[6:7] offset:64
    global_load_dwordx4 a[40:43], v13, s[6:7] offset:128
    global_load_dwordx4 a[44:47], v13, s[6:7] offset:192
    v_add_u32 v13, 0x4000, v13
    global_load_dwordx4 a[48:51], v13, s[6:7] offset:0
    global_load_dwordx4 a[52:55], v13, s[6:7] offset:64
    global_load_dwordx4 a[56:59], v13, s[6:7] offset:128
    global_load_dwordx4 a[60:63], v13, s[6:7] offset:192
    v_add_u32 v13, 0x4000, v13
    s_branch K2_BAR
K2_APRE:
    s_load_dwordx2 s[6:7], s[0:1], 8
    s_load_dwordx2 s[8:9], s[0:1], 16
    s_sub_u32 s23, s2, 128
    s_lshr_b32 s24, s23, 3
    s_and_b32 s25, s23, 7
    s_waitcnt lgkmcnt(0)
    s_lshl_b32 s26, s24, 21
    s_lshl_b32 s27, s25, 16
    s_add_u32 s26, s26, s27
    s_lshl_b32 s27, s22, 14
    s_add_u32 s26, s26, s27
    s_add_u32 s26, s26, 1572864
    s_add_u32 s6, s6, s26
    s_addc_u32 s7, s7, 0
    s_add_u32 s8, s8, s26
    s_addc_u32 s9, s9, 0
    v_lshlrev_b32 v10, 8, v8
    v_lshlrev_b32 v11, 4, v9
    v_add_u32 v10, v10, v11
    v_mov_b32 v13, v10
    v_mov_b32 v12, v10
    global_load_dwordx4 a[0:3], v12, s[6:7] offset:0
    global_load_dwordx4 a[4:7], v12, s[6:7] offset:64
    global_load_dwordx4 a[8:11], v12, s[6:7] offset:128
    global_load_dwordx4 a[12:15], v12, s[6:7] offset:192
    v_add_u32 v12, 0x1000, v12
    global_load_dwordx4 a[16:19], v12, s[6:7] offset:0
    global_load_dwordx4 a[20:23], v12, s[6:7] offset:64
    global_load_dwordx4 a[24:27], v12, s[6:7] offset:128
    global_load_dwordx4 a[28:31], v12, s[6:7] offset:192
    v_add_u32 v12, 0x1000, v12
    global_load_dwordx4 a[32:35], v12, s[6:7] offset:0
    global_load_dwordx4 a[36:39], v12, s[6:7] offset:64
    global_load_dwordx4 a[40:43], v12, s[6:7] offset:128
    global_load_dwordx4 a[44:47], v12, s[6:7] offset:192
    v_add_u32 v12, 0x1000, v12
    global_load_dwordx4 a[48:51], v12, s[6:7] offset:0
    global_load_dwordx4 a[52:55], v12, s[6:7] offset:64
    global_load_dwordx4 a[56:59], v12, s[6:7] offset:128
    global_load_dwordx4 a[60:63], v12, s[6:7] offset:192
    v_lshlrev_b32 v12, 4, v6
    global_load_dwordx4 a[64:67], v12, s[8:9] offset:0
    global_load_dwordx4 a[68:71], v12, s[8:9] offset:1024
    global_load_dwordx4 a[72:75], v12, s[8:9] offset:2048
    global_load_dwordx4 a[76:79], v12, s[8:9] offset:3072
    v_add_u32 v12, 0x1000, v12
    global_load_dwordx4 a[80:83], v12, s[8:9] offset:0
    global_load_dwordx4 a[84:87], v12, s[8:9] offset:1024
    global_load_dwordx4 a[88:91], v12, s[8:9] offset:2048
    global_load_dwordx4 a[92:95], v12, s[8:9] offset:3072
    v_add_u32 v12, 0x1000, v12
    global_load_dwordx4 a[96:99], v12, s[8:9] offset:0
    global_load_dwordx4 a[100:103], v12, s[8:9] offset:1024
    global_load_dwordx4 a[104:107], v12, s[8:9] offset:2048
    global_load_dwordx4 a[108:111], v12, s[8:9] offset:3072
    v_add_u32 v12, 0x1000, v12
    global_load_dwordx4 a[112:115], v12, s[8:9] offset:0
    global_load_dwordx4 a[116:119], v12, s[8:9] offset:1024
    global_load_dwordx4 a[120:123], v12, s[8:9] offset:2048
    global_load_dwordx4 a[124:127], v12, s[8:9] offset:3072
K2_BAR:
    s_cmp_ge_u32 s2, 128
    s_cbranch_scc1 K2_A
    s_mul_i32 s26, s22, 9216
    s_add_u32 s26, s26, 12288
    v_mul_u32_u24 v14, 288, v8
    v_lshlrev_b32 v15, 4, v9
    v_add3_u32 v14, v14, v15, s26
    v_lshrrev_b32 v15, 2, v8
    v_lshl_add_u32 v15, v9, 2, v15
    v_mul_u32_u24 v15, 288, v15
    v_and_b32 v16, 3, v6
    v_lshlrev_b32 v16, 3, v16
    v_add3_u32 v15, v15, v16, s26
    s_waitcnt vmcnt(8)
    v_mfma_f32_16x16x32_bf16 v[224:227], a[0:3], v[192:195], 0
    v_mfma_f32_16x16x32_bf16 v[228:231], a[0:3], v[208:211], 0
    v_mfma_f32_16x16x32_bf16 v[232:235], a[16:19], v[192:195], 0
    v_mfma_f32_16x16x32_bf16 v[236:239], a[16:19], v[208:211], 0
    v_mfma_f32_16x16x32_bf16 v[224:227], a[4:7], v[196:199], v[224:227]
    v_mfma_f32_16x16x32_bf16 v[228:231], a[4:7], v[212:215], v[228:231]
    v_mfma_f32_16x16x32_bf16 v[232:235], a[20:23], v[196:199], v[232:235]
    v_mfma_f32_16x16x32_bf16 v[236:239], a[20:23], v[212:215], v[236:239]
    v_mfma_f32_16x16x32_bf16 v[224:227], a[8:11], v[200:203], v[224:227]
    v_mfma_f32_16x16x32_bf16 v[228:231], a[8:11], v[216:219], v[228:231]
    v_mfma_f32_16x16x32_bf16 v[232:235], a[24:27], v[200:203], v[232:235]
    v_mfma_f32_16x16x32_bf16 v[236:239], a[24:27], v[216:219], v[236:239]
    v_mfma_f32_16x16x32_bf16 v[224:227], a[12:15], v[204:207], v[224:227]
    v_mfma_f32_16x16x32_bf16 v[228:231], a[12:15], v[220:223], v[228:231]
    v_mfma_f32_16x16x32_bf16 v[232:235], a[28:31], v[204:207], v[232:235]
    v_mfma_f32_16x16x32_bf16 v[236:239], a[28:31], v[220:223], v[236:239]
    global_load_dwordx4 a[64:67], v13, s[6:7] offset:0
    global_load_dwordx4 a[68:71], v13, s[6:7] offset:64
    global_load_dwordx4 a[72:75], v13, s[6:7] offset:128
    global_load_dwordx4 a[76:79], v13, s[6:7] offset:192
    v_add_u32 v13, 0x4000, v13
    global_load_dwordx4 a[80:83], v13, s[6:7] offset:0
    global_load_dwordx4 a[84:87], v13, s[6:7] offset:64
    global_load_dwordx4 a[88:91], v13, s[6:7] offset:128
    global_load_dwordx4 a[92:95], v13, s[6:7] offset:192
    v_add_u32 v13, 0x4000, v13
    ds_write_b128 v14, a[0:3] offset:0
    ds_write_b128 v14, a[4:7] offset:64
    ds_write_b128 v14, a[8:11] offset:128
    ds_write_b128 v14, a[12:15] offset:192
    ds_write_b128 v14, a[16:19] offset:4608
    ds_write_b128 v14, a[20:23] offset:4672
    ds_write_b128 v14, a[24:27] offset:4736
    ds_write_b128 v14, a[28:31] offset:4800
    s_waitcnt lgkmcnt(0)
    ds_read_b64_tr_b16 v[64:65], v15 offset:0
    ds_read_b64_tr_b16 v[66:67], v15 offset:4608
    ds_read_b64_tr_b16 v[68:69], v15 offset:32
    ds_read_b64_tr_b16 v[70:71], v15 offset:4640
    ds_read_b64_tr_b16 v[72:73], v15 offset:64
    ds_read_b64_tr_b16 v[74:75], v15 offset:4672
    ds_read_b64_tr_b16 v[76:77], v15 offset:96
    ds_read_b64_tr_b16 v[78:79], v15 offset:4704
    ds_read_b64_tr_b16 v[80:81], v15 offset:128
    ds_read_b64_tr_b16 v[82:83], v15 offset:4736
    ds_read_b64_tr_b16 v[84:85], v15 offset:160
    ds_read_b64_tr_b16 v[86:87], v15 offset:4768
    ds_read_b64_tr_b16 v[88:89], v15 offset:192
    ds_read_b64_tr_b16 v[90:91], v15 offset:4800
    ds_read_b64_tr_b16 v[92:93], v15 offset:224
    ds_read_b64_tr_b16 v[94:95], v15 offset:4832
    s_waitcnt lgkmcnt(0)
    s_waitcnt vmcnt(8)
    v_mfma_f32_16x16x32_bf16 v[240:243], a[32:35], v[192:195], 0
    v_mfma_f32_16x16x32_bf16 v[244:247], a[32:35], v[208:211], 0
    v_mfma_f32_16x16x32_bf16 v[248:251], a[48:51], v[192:195], 0
    v_mfma_f32_16x16x32_bf16 v[252:255], a[48:51], v[208:211], 0
    v_mfma_f32_16x16x32_bf16 v[240:243], a[36:39], v[196:199], v[240:243]
    v_mfma_f32_16x16x32_bf16 v[244:247], a[36:39], v[212:215], v[244:247]
    v_mfma_f32_16x16x32_bf16 v[248:251], a[52:55], v[196:199], v[248:251]
    v_mfma_f32_16x16x32_bf16 v[252:255], a[52:55], v[212:215], v[252:255]
    v_mfma_f32_16x16x32_bf16 v[240:243], a[40:43], v[200:203], v[240:243]
    v_mfma_f32_16x16x32_bf16 v[244:247], a[40:43], v[216:219], v[244:247]
    v_mfma_f32_16x16x32_bf16 v[248:251], a[56:59], v[200:203], v[248:251]
    v_mfma_f32_16x16x32_bf16 v[252:255], a[56:59], v[216:219], v[252:255]
    v_mfma_f32_16x16x32_bf16 v[240:243], a[44:47], v[204:207], v[240:243]
    v_mfma_f32_16x16x32_bf16 v[244:247], a[44:47], v[220:223], v[244:247]
    v_mfma_f32_16x16x32_bf16 v[248:251], a[60:63], v[204:207], v[248:251]
    v_mfma_f32_16x16x32_bf16 v[252:255], a[60:63], v[220:223], v[252:255]
    global_load_dwordx4 a[96:99], v13, s[6:7] offset:0
    global_load_dwordx4 a[100:103], v13, s[6:7] offset:64
    global_load_dwordx4 a[104:107], v13, s[6:7] offset:128
    global_load_dwordx4 a[108:111], v13, s[6:7] offset:192
    v_add_u32 v13, 0x4000, v13
    global_load_dwordx4 a[112:115], v13, s[6:7] offset:0
    global_load_dwordx4 a[116:119], v13, s[6:7] offset:64
    global_load_dwordx4 a[120:123], v13, s[6:7] offset:128
    global_load_dwordx4 a[124:127], v13, s[6:7] offset:192
    ds_write_b128 v14, a[32:35] offset:0
    ds_write_b128 v14, a[36:39] offset:64
    ds_write_b128 v14, a[40:43] offset:128
    ds_write_b128 v14, a[44:47] offset:192
    ds_write_b128 v14, a[48:51] offset:4608
    ds_write_b128 v14, a[52:55] offset:4672
    ds_write_b128 v14, a[56:59] offset:4736
    ds_write_b128 v14, a[60:63] offset:4800
    s_waitcnt lgkmcnt(0)
    ds_read_b64_tr_b16 v[96:97], v15 offset:0
    ds_read_b64_tr_b16 v[98:99], v15 offset:4608
    ds_read_b64_tr_b16 v[100:101], v15 offset:32
    ds_read_b64_tr_b16 v[102:103], v15 offset:4640
    ds_read_b64_tr_b16 v[104:105], v15 offset:64
    ds_read_b64_tr_b16 v[106:107], v15 offset:4672
    ds_read_b64_tr_b16 v[108:109], v15 offset:96
    ds_read_b64_tr_b16 v[110:111], v15 offset:4704
    ds_read_b64_tr_b16 v[112:113], v15 offset:128
    ds_read_b64_tr_b16 v[114:115], v15 offset:4736
    ds_read_b64_tr_b16 v[116:117], v15 offset:160
    ds_read_b64_tr_b16 v[118:119], v15 offset:4768
    ds_read_b64_tr_b16 v[120:121], v15 offset:192
    ds_read_b64_tr_b16 v[122:123], v15 offset:4800
    ds_read_b64_tr_b16 v[124:125], v15 offset:224
    ds_read_b64_tr_b16 v[126:127], v15 offset:4832
    s_waitcnt lgkmcnt(0)
    s_waitcnt vmcnt(8)
    v_mfma_f32_16x16x32_bf16 v[32:35], a[64:67], v[192:195], 0
    v_mfma_f32_16x16x32_bf16 v[36:39], a[64:67], v[208:211], 0
    v_mfma_f32_16x16x32_bf16 v[40:43], a[80:83], v[192:195], 0
    v_mfma_f32_16x16x32_bf16 v[44:47], a[80:83], v[208:211], 0
    v_mfma_f32_16x16x32_bf16 v[32:35], a[68:71], v[196:199], v[32:35]
    v_mfma_f32_16x16x32_bf16 v[36:39], a[68:71], v[212:215], v[36:39]
    v_mfma_f32_16x16x32_bf16 v[40:43], a[84:87], v[196:199], v[40:43]
    v_mfma_f32_16x16x32_bf16 v[44:47], a[84:87], v[212:215], v[44:47]
    v_mfma_f32_16x16x32_bf16 v[32:35], a[72:75], v[200:203], v[32:35]
    v_mfma_f32_16x16x32_bf16 v[36:39], a[72:75], v[216:219], v[36:39]
    v_mfma_f32_16x16x32_bf16 v[40:43], a[88:91], v[200:203], v[40:43]
    v_mfma_f32_16x16x32_bf16 v[44:47], a[88:91], v[216:219], v[44:47]
    v_mfma_f32_16x16x32_bf16 v[32:35], a[76:79], v[204:207], v[32:35]
    v_mfma_f32_16x16x32_bf16 v[36:39], a[76:79], v[220:223], v[36:39]
    v_mfma_f32_16x16x32_bf16 v[40:43], a[92:95], v[204:207], v[40:43]
    v_mfma_f32_16x16x32_bf16 v[44:47], a[92:95], v[220:223], v[44:47]
    ds_write_b128 v14, a[64:67] offset:0
    ds_write_b128 v14, a[68:71] offset:64
    ds_write_b128 v14, a[72:75] offset:128
    ds_write_b128 v14, a[76:79] offset:192
    ds_write_b128 v14, a[80:83] offset:4608
    ds_write_b128 v14, a[84:87] offset:4672
    ds_write_b128 v14, a[88:91] offset:4736
    ds_write_b128 v14, a[92:95] offset:4800
    s_waitcnt lgkmcnt(0)
    ds_read_b64_tr_b16 v[128:129], v15 offset:0
    ds_read_b64_tr_b16 v[130:131], v15 offset:4608
    ds_read_b64_tr_b16 v[132:133], v15 offset:32
    ds_read_b64_tr_b16 v[134:135], v15 offset:4640
    ds_read_b64_tr_b16 v[136:137], v15 offset:64
    ds_read_b64_tr_b16 v[138:139], v15 offset:4672
    ds_read_b64_tr_b16 v[140:141], v15 offset:96
    ds_read_b64_tr_b16 v[142:143], v15 offset:4704
    ds_read_b64_tr_b16 v[144:145], v15 offset:128
    ds_read_b64_tr_b16 v[146:147], v15 offset:4736
    ds_read_b64_tr_b16 v[148:149], v15 offset:160
    ds_read_b64_tr_b16 v[150:151], v15 offset:4768
    ds_read_b64_tr_b16 v[152:153], v15 offset:192
    ds_read_b64_tr_b16 v[154:155], v15 offset:4800
    ds_read_b64_tr_b16 v[156:157], v15 offset:224
    ds_read_b64_tr_b16 v[158:159], v15 offset:4832
    s_waitcnt lgkmcnt(0)
    s_waitcnt vmcnt(0)
    v_mfma_f32_16x16x32_bf16 v[48:51], a[96:99], v[192:195], 0
    v_mfma_f32_16x16x32_bf16 v[52:55], a[96:99], v[208:211], 0
    v_mfma_f32_16x16x32_bf16 v[56:59], a[112:115], v[192:195], 0
    v_mfma_f32_16x16x32_bf16 v[60:63], a[112:115], v[208:211], 0
    v_mfma_f32_16x16x32_bf16 v[48:51], a[100:103], v[196:199], v[48:51]
    v_mfma_f32_16x16x32_bf16 v[52:55], a[100:103], v[212:215], v[52:55]
    v_mfma_f32_16x16x32_bf16 v[56:59], a[116:119], v[196:199], v[56:59]
    v_mfma_f32_16x16x32_bf16 v[60:63], a[116:119], v[212:215], v[60:63]
    v_mfma_f32_16x16x32_bf16 v[48:51], a[104:107], v[200:203], v[48:51]
    v_mfma_f32_16x16x32_bf16 v[52:55], a[104:107], v[216:219], v[52:55]
    v_mfma_f32_16x16x32_bf16 v[56:59], a[120:123], v[200:203], v[56:59]
    v_mfma_f32_16x16x32_bf16 v[60:63], a[120:123], v[216:219], v[60:63]
    v_mfma_f32_16x16x32_bf16 v[48:51], a[108:111], v[204:207], v[48:51]
    v_mfma_f32_16x16x32_bf16 v[52:55], a[108:111], v[220:223], v[52:55]
    v_mfma_f32_16x16x32_bf16 v[56:59], a[124:127], v[204:207], v[56:59]
    v_mfma_f32_16x16x32_bf16 v[60:63], a[124:127], v[220:223], v[60:63]
    ds_write_b128 v14, a[96:99] offset:0
    ds_write_b128 v14, a[100:103] offset:64
    ds_write_b128 v14, a[104:107] offset:128
    ds_write_b128 v14, a[108:111] offset:192
    ds_write_b128 v14, a[112:115] offset:4608
    ds_write_b128 v14, a[116:119] offset:4672
    ds_write_b128 v14, a[120:123] offset:4736
    ds_write_b128 v14, a[124:127] offset:4800
    s_waitcnt lgkmcnt(0)
    ds_read_b64_tr_b16 v[160:161], v15 offset:0
    ds_read_b64_tr_b16 v[162:163], v15 offset:4608
    ds_read_b64_tr_b16 v[164:165], v15 offset:32
    ds_read_b64_tr_b16 v[166:167], v15 offset:4640
    ds_read_b64_tr_b16 v[168:169], v15 offset:64
    ds_read_b64_tr_b16 v[170:171], v15 offset:4672
    ds_read_b64_tr_b16 v[172:173], v15 offset:96
    ds_read_b64_tr_b16 v[174:175], v15 offset:4704
    ds_read_b64_tr_b16 v[176:177], v15 offset:128
    ds_read_b64_tr_b16 v[178:179], v15 offset:4736
    ds_read_b64_tr_b16 v[180:181], v15 offset:160
    ds_read_b64_tr_b16 v[182:183], v15 offset:4768
    ds_read_b64_tr_b16 v[184:185], v15 offset:192
    ds_read_b64_tr_b16 v[186:187], v15 offset:4800
    ds_read_b64_tr_b16 v[188:189], v15 offset:224
    ds_read_b64_tr_b16 v[190:191], v15 offset:4832
    s_waitcnt lgkmcnt(0)
    s_lshl_b32 s26, s22, 14
    s_add_u32 s26, s26, 49152
    v_lshlrev_b32 v16, 4, v6
    v_add_u32 v17, s26, v16
    ds_write_b128 v17, v[224:227] offset:0
    ds_write_b128 v17, v[228:231] offset:1024
    ds_write_b128 v17, v[232:235] offset:2048
    ds_write_b128 v17, v[236:239] offset:3072
    ds_write_b128 v17, v[240:243] offset:4096
    ds_write_b128 v17, v[244:247] offset:5120
    ds_write_b128 v17, v[248:251] offset:6144
    ds_write_b128 v17, v[252:255] offset:7168
    ds_write_b128 v17, v[32:35] offset:8192
    ds_write_b128 v17, v[36:39] offset:9216
    ds_write_b128 v17, v[40:43] offset:10240
    ds_write_b128 v17, v[44:47] offset:11264
    ds_write_b128 v17, v[48:51] offset:12288
    ds_write_b128 v17, v[52:55] offset:13312
    ds_write_b128 v17, v[56:59] offset:14336
    ds_write_b128 v17, v[60:63] offset:15360
    s_waitcnt lgkmcnt(0)
    s_barrier
    s_lshl_b32 s26, s22, 12
    s_add_u32 s26, s26, 49152
    v_add_u32 v17, s26, v16
    ds_read_b128 v[224:227], v17 offset:0
    ds_read_b128 v[228:231], v17 offset:1024
    ds_read_b128 v[232:235], v17 offset:2048
    ds_read_b128 v[236:239], v17 offset:3072
    ds_read_b128 v[240:243], v17 offset:16384
    ds_read_b128 v[244:247], v17 offset:17408
    ds_read_b128 v[248:251], v17 offset:18432
    ds_read_b128 v[252:255], v17 offset:19456
    ds_read_b128 v[32:35], v17 offset:32768
    ds_read_b128 v[36:39], v17 offset:33792
    ds_read_b128 v[40:43], v17 offset:34816
    ds_read_b128 v[44:47], v17 offset:35840
    ds_read_b128 v[48:51], v17 offset:49152
    ds_read_b128 v[52:55], v17 offset:50176
    ds_read_b128 v[56:59], v17 offset:51200
    ds_read_b128 v[60:63], v17 offset:52224
    s_waitcnt lgkmcnt(0)
    v_add_f32 v224, v224, v240
    v_add_f32 v224, v224, v32
    v_add_f32 v224, v224, v48
    v_add_f32 v225, v225, v241
    v_add_f32 v225, v225, v33
    v_add_f32 v225, v225, v49
    v_add_f32 v226, v226, v242
    v_add_f32 v226, v226, v34
    v_add_f32 v226, v226, v50
    v_add_f32 v227, v227, v243
    v_add_f32 v227, v227, v35
    v_add_f32 v227, v227, v51
    v_add_f32 v228, v228, v244
    v_add_f32 v228, v228, v36
    v_add_f32 v228, v228, v52
    v_add_f32 v229, v229, v245
    v_add_f32 v229, v229, v37
    v_add_f32 v229, v229, v53
    v_add_f32 v230, v230, v246
    v_add_f32 v230, v230, v38
    v_add_f32 v230, v230, v54
    v_add_f32 v231, v231, v247
    v_add_f32 v231, v231, v39
    v_add_f32 v231, v231, v55
    v_add_f32 v232, v232, v248
    v_add_f32 v232, v232, v40
    v_add_f32 v232, v232, v56
    v_add_f32 v233, v233, v249
    v_add_f32 v233, v233, v41
    v_add_f32 v233, v233, v57
    v_add_f32 v234, v234, v250
    v_add_f32 v234, v234, v42
    v_add_f32 v234, v234, v58
    v_add_f32 v235, v235, v251
    v_add_f32 v235, v235, v43
    v_add_f32 v235, v235, v59
    v_add_f32 v236, v236, v252
    v_add_f32 v236, v236, v44
    v_add_f32 v236, v236, v60
    v_add_f32 v237, v237, v253
    v_add_f32 v237, v237, v45
    v_add_f32 v237, v237, v61
    v_add_f32 v238, v238, v254
    v_add_f32 v238, v238, v46
    v_add_f32 v238, v238, v62
    v_add_f32 v239, v239, v255
    v_add_f32 v239, v239, v47
    v_add_f32 v239, v239, v63
    v_cvt_pk_bf16_f32 v18, v224, v225
    v_lshlrev_b32 v224, 16, v18
    v_and_b32 v225, 0xffff0000, v18
    v_mul_f32 v224, s20, v224
    v_mul_f32 v225, s20, v225
    v_cvt_pk_bf16_f32 v18, v224, v225
    v_lshlrev_b32 v224, 16, v18
    v_and_b32 v225, 0xffff0000, v18
    v_cvt_pk_bf16_f32 v18, v226, v227
    v_lshlrev_b32 v226, 16, v18
    v_and_b32 v227, 0xffff0000, v18
    v_mul_f32 v226, s20, v226
    v_mul_f32 v227, s20, v227
    v_cvt_pk_bf16_f32 v18, v226, v227
    v_lshlrev_b32 v226, 16, v18
    v_and_b32 v227, 0xffff0000, v18
    v_cvt_pk_bf16_f32 v18, v228, v229
    v_lshlrev_b32 v228, 16, v18
    v_and_b32 v229, 0xffff0000, v18
    v_mul_f32 v228, s20, v228
    v_mul_f32 v229, s20, v229
    v_cvt_pk_bf16_f32 v18, v228, v229
    v_lshlrev_b32 v228, 16, v18
    v_and_b32 v229, 0xffff0000, v18
    v_cvt_pk_bf16_f32 v18, v230, v231
    v_lshlrev_b32 v230, 16, v18
    v_and_b32 v231, 0xffff0000, v18
    v_mul_f32 v230, s20, v230
    v_mul_f32 v231, s20, v231
    v_cvt_pk_bf16_f32 v18, v230, v231
    v_lshlrev_b32 v230, 16, v18
    v_and_b32 v231, 0xffff0000, v18
    v_cvt_pk_bf16_f32 v18, v232, v233
    v_lshlrev_b32 v232, 16, v18
    v_and_b32 v233, 0xffff0000, v18
    v_mul_f32 v232, s20, v232
    v_mul_f32 v233, s20, v233
    v_cvt_pk_bf16_f32 v18, v232, v233
    v_lshlrev_b32 v232, 16, v18
    v_and_b32 v233, 0xffff0000, v18
    v_cvt_pk_bf16_f32 v18, v234, v235
    v_lshlrev_b32 v234, 16, v18
    v_and_b32 v235, 0xffff0000, v18
    v_mul_f32 v234, s20, v234
    v_mul_f32 v235, s20, v235
    v_cvt_pk_bf16_f32 v18, v234, v235
    v_lshlrev_b32 v234, 16, v18
    v_and_b32 v235, 0xffff0000, v18
    v_cvt_pk_bf16_f32 v18, v236, v237
    v_lshlrev_b32 v236, 16, v18
    v_and_b32 v237, 0xffff0000, v18
    v_mul_f32 v236, s20, v236
    v_mul_f32 v237, s20, v237
    v_cvt_pk_bf16_f32 v18, v236, v237
    v_lshlrev_b32 v236, 16, v18
    v_and_b32 v237, 0xffff0000, v18
    v_cvt_pk_bf16_f32 v18, v238, v239
    v_lshlrev_b32 v238, 16, v18
    v_and_b32 v239, 0xffff0000, v18
    v_mul_f32 v238, s20, v238
    v_mul_f32 v239, s20, v239
    v_cvt_pk_bf16_f32 v18, v238, v239
    v_lshlrev_b32 v238, 16, v18
    v_and_b32 v239, 0xffff0000, v18
    v_max3_f32 v20, v224, v225, v226
    v_max3_f32 v20, v20, v227, v232
    v_max3_f32 v20, v20, v233, v234
    v_max_f32 v20, v20, v235
    v_max3_f32 v21, v228, v229, v230
    v_max3_f32 v21, v21, v231, v236
    v_max3_f32 v21, v21, v237, v238
    v_max_f32 v21, v21, v239
    v_lshlrev_b32 v18, 6, v8
    v_lshlrev_b32 v19, 2, v9
    s_lshl_b32 s26, s22, 4
    v_add3_u32 v19, v18, v19, s26
    ds_write_b32 v19, v20 offset:8192
    ds_write_b32 v19, v21 offset:9216
    s_waitcnt lgkmcnt(0)
    s_barrier
    ds_read_b128 v[240:243], v18 offset:8192
    ds_read_b128 v[244:247], v18 offset:8208
    ds_read_b128 v[248:251], v18 offset:8224
    ds_read_b128 v[252:255], v18 offset:8240
    ds_read_b128 v[32:35], v18 offset:9216
    ds_read_b128 v[36:39], v18 offset:9232
    ds_read_b128 v[40:43], v18 offset:9248
    ds_read_b128 v[44:47], v18 offset:9264
    s_waitcnt lgkmcnt(0)
    v_max3_f32 v20, v240, v241, v242
    v_max3_f32 v20, v20, v243, v244
    v_max3_f32 v20, v20, v245, v246
    v_max3_f32 v20, v20, v247, v248
    v_max3_f32 v20, v20, v249, v250
    v_max3_f32 v20, v20, v251, v252
    v_max3_f32 v20, v20, v253, v254
    v_max_f32 v20, v20, v255
    v_max3_f32 v21, v32, v33, v34
    v_max3_f32 v21, v21, v35, v36
    v_max3_f32 v21, v21, v37, v38
    v_max3_f32 v21, v21, v39, v40
    v_max3_f32 v21, v21, v41, v42
    v_max3_f32 v21, v21, v43, v44
    v_max3_f32 v21, v21, v45, v46
    v_max_f32 v21, v21, v47
    v_sub_f32 v224, v224, v20
    v_mul_f32 v224, s21, v224
    v_exp_f32 v224, v224
    v_sub_f32 v225, v225, v20
    v_mul_f32 v225, s21, v225
    v_exp_f32 v225, v225
    v_sub_f32 v226, v226, v20
    v_mul_f32 v226, s21, v226
    v_exp_f32 v226, v226
    v_sub_f32 v227, v227, v20
    v_mul_f32 v227, s21, v227
    v_exp_f32 v227, v227
    v_sub_f32 v232, v232, v20
    v_mul_f32 v232, s21, v232
    v_exp_f32 v232, v232
    v_sub_f32 v233, v233, v20
    v_mul_f32 v233, s21, v233
    v_exp_f32 v233, v233
    v_sub_f32 v234, v234, v20
    v_mul_f32 v234, s21, v234
    v_exp_f32 v234, v234
    v_sub_f32 v235, v235, v20
    v_mul_f32 v235, s21, v235
    v_exp_f32 v235, v235
    s_nop 1
    v_add_f32 v22, v224, v225
    v_add_f32 v22, v22, v226
    v_add_f32 v22, v22, v227
    v_add_f32 v22, v22, v232
    v_add_f32 v22, v22, v233
    v_add_f32 v22, v22, v234
    v_add_f32 v22, v22, v235
    v_sub_f32 v228, v228, v21
    v_mul_f32 v228, s21, v228
    v_exp_f32 v228, v228
    v_sub_f32 v229, v229, v21
    v_mul_f32 v229, s21, v229
    v_exp_f32 v229, v229
    v_sub_f32 v230, v230, v21
    v_mul_f32 v230, s21, v230
    v_exp_f32 v230, v230
    v_sub_f32 v231, v231, v21
    v_mul_f32 v231, s21, v231
    v_exp_f32 v231, v231
    v_sub_f32 v236, v236, v21
    v_mul_f32 v236, s21, v236
    v_exp_f32 v236, v236
    v_sub_f32 v237, v237, v21
    v_mul_f32 v237, s21, v237
    v_exp_f32 v237, v237
    v_sub_f32 v238, v238, v21
    v_mul_f32 v238, s21, v238
    v_exp_f32 v238, v238
    v_sub_f32 v239, v239, v21
    v_mul_f32 v239, s21, v239
    v_exp_f32 v239, v239
    s_nop 1
    v_add_f32 v23, v228, v229
    v_add_f32 v23, v23, v230
    v_add_f32 v23, v23, v231
    v_add_f32 v23, v23, v236
    v_add_f32 v23, v23, v237
    v_add_f32 v23, v23, v238
    v_add_f32 v23, v23, v239
    ds_write_b32 v19, v22 offset:10240
    ds_write_b32 v19, v23 offset:11264
    v_cvt_pk_bf16_f32 v24, v224, v225
    v_cvt_pk_bf16_f32 v25, v226, v227
    v_cvt_pk_bf16_f32 v26, v232, v233
    v_cvt_pk_bf16_f32 v27, v234, v235
    v_cvt_pk_bf16_f32 v28, v228, v229
    v_cvt_pk_bf16_f32 v29, v230, v231
    v_cvt_pk_bf16_f32 v30, v236, v237
    v_cvt_pk_bf16_f32 v31, v238, v239
    s_lshl_b32 s26, s22, 11
    v_add_u32 v17, s26, v16
    ds_write_b128 v17, v[24:27] offset:0
    ds_write_b128 v17, v[28:31] offset:1024
    s_waitcnt lgkmcnt(0)
    s_barrier
    ds_read_b128 v[192:195], v16 offset:0
    ds_read_b128 v[196:199], v16 offset:1024
    ds_read_b128 v[200:203], v16 offset:2048
    ds_read_b128 v[204:207], v16 offset:3072
    ds_read_b128 v[208:211], v16 offset:4096
    ds_read_b128 v[212:215], v16 offset:5120
    ds_read_b128 v[216:219], v16 offset:6144
    ds_read_b128 v[220:223], v16 offset:7168
    s_cmp_lg_u32 s22, 0
    s_cbranch_scc1 K2B_NOSTAT
    v_cmp_gt_u32 vcc, 16, v6
    s_nop 1
    s_and_saveexec_b64 s[16:17], vcc
    ds_read_b128 v[224:227], v18 offset:10240
    ds_read_b128 v[228:231], v18 offset:10256
    ds_read_b128 v[232:235], v18 offset:10272
    ds_read_b128 v[236:239], v18 offset:10288
    ds_read_b128 v[240:243], v18 offset:11264
    ds_read_b128 v[244:247], v18 offset:11280
    ds_read_b128 v[248:251], v18 offset:11296
    ds_read_b128 v[252:255], v18 offset:11312
    s_waitcnt lgkmcnt(0)
    v_add_f32 v224, v224, v225
    v_add_f32 v224, v224, v226
    v_add_f32 v224, v224, v227
    v_add_f32 v224, v224, v228
    v_add_f32 v224, v224, v229
    v_add_f32 v224, v224, v230
    v_add_f32 v224, v224, v231
    v_add_f32 v224, v224, v232
    v_add_f32 v224, v224, v233
    v_add_f32 v224, v224, v234
    v_add_f32 v224, v224, v235
    v_add_f32 v224, v224, v236
    v_add_f32 v224, v224, v237
    v_add_f32 v224, v224, v238
    v_add_f32 v224, v224, v239
    v_add_f32 v240, v240, v241
    v_add_f32 v240, v240, v242
    v_add_f32 v240, v240, v243
    v_add_f32 v240, v240, v244
    v_add_f32 v240, v240, v245
    v_add_f32 v240, v240, v246
    v_add_f32 v240, v240, v247
    v_add_f32 v240, v240, v248
    v_add_f32 v240, v240, v249
    v_add_f32 v240, v240, v250
    v_add_f32 v240, v240, v251
    v_add_f32 v240, v240, v252
    v_add_f32 v240, v240, v253
    v_add_f32 v240, v240, v254
    v_add_f32 v240, v240, v255
    v_mov_b32 v26, v20
    v_mov_b32 v27, v224
    v_mov_b32 v28, v21
    v_mov_b32 v29, v240
    s_lshl_b32 s26, s2, 8
    s_add_u32 s26, s26, 0x210000
    v_lshlrev_b32 v30, 3, v8
    v_add_u32 v30, s26, v30
    global_store_dwordx2 v30, v[26:27], s[4:5]
    global_store_dwordx2 v30, v[28:29], s[4:5] offset:128
    s_mov_b64 exec, s[16:17]
K2B_NOSTAT:
    s_waitcnt lgkmcnt(0)
    s_lshl_b32 s26, s2, 15
    s_lshl_b32 s27, s22, 8
    s_add_u32 s26, s26, s27
    s_add_u32 s26, s26, 0x400000
    s_add_u32 s28, s4, s26
    s_addc_u32 s29, s5, 0
    v_lshlrev_b32 v17, 10, v8
    v_lshlrev_b32 v18, 3, v9
    v_add_u32 v17, v17, v18
    v_add_u32 v18, 0x4000, v17
    s_nop 1
    v_mfma_f32_16x16x32_bf16 v[224:227], v[64:67], v[192:195], 0
    v_mfma_f32_16x16x32_bf16 v[228:231], v[64:67], v[196:199], 0
    v_mfma_f32_16x16x32_bf16 v[224:227], v[96:99], v[200:203], v[224:227]
    v_mfma_f32_16x16x32_bf16 v[228:231], v[96:99], v[204:207], v[228:231]
    v_mfma_f32_16x16x32_bf16 v[224:227], v[128:131], v[208:211], v[224:227]
    v_mfma_f32_16x16x32_bf16 v[228:231], v[128:131], v[212:215], v[228:231]
    v_mfma_f32_16x16x32_bf16 v[224:227], v[160:163], v[216:219], v[224:227]
    v_mfma_f32_16x16x32_bf16 v[228:231], v[160:163], v[220:223], v[228:231]
    v_mfma_f32_16x16x32_bf16 v[232:235], v[68:71], v[192:195], 0
    v_mfma_f32_16x16x32_bf16 v[236:239], v[68:71], v[196:199], 0
    v_mfma_f32_16x16x32_bf16 v[232:235], v[100:103], v[200:203], v[232:235]
    v_mfma_f32_16x16x32_bf16 v[236:239], v[100:103], v[204:207], v[236:239]
    v_mfma_f32_16x16x32_bf16 v[232:235], v[132:135], v[208:211], v[232:235]
    v_mfma_f32_16x16x32_bf16 v[236:239], v[132:135], v[212:215], v[236:239]
    v_mfma_f32_16x16x32_bf16 v[232:235], v[164:167], v[216:219], v[232:235]
    v_mfma_f32_16x16x32_bf16 v[236:239], v[164:167], v[220:223], v[236:239]
    v_cvt_pk_bf16_f32 v24, v224, v225
    v_cvt_pk_bf16_f32 v25, v226, v227
    global_store_dwordx2 v17, v[24:25], s[28:29] offset:0
    v_cvt_pk_bf16_f32 v26, v228, v229
    v_cvt_pk_bf16_f32 v27, v230, v231
    global_store_dwordx2 v18, v[26:27], s[28:29] offset:0
    v_mfma_f32_16x16x32_bf16 v[240:243], v[72:75], v[192:195], 0
    v_mfma_f32_16x16x32_bf16 v[244:247], v[72:75], v[196:199], 0
    v_mfma_f32_16x16x32_bf16 v[240:243], v[104:107], v[200:203], v[240:243]
    v_mfma_f32_16x16x32_bf16 v[244:247], v[104:107], v[204:207], v[244:247]
    v_mfma_f32_16x16x32_bf16 v[240:243], v[136:139], v[208:211], v[240:243]
    v_mfma_f32_16x16x32_bf16 v[244:247], v[136:139], v[212:215], v[244:247]
    v_mfma_f32_16x16x32_bf16 v[240:243], v[168:171], v[216:219], v[240:243]
    v_mfma_f32_16x16x32_bf16 v[244:247], v[168:171], v[220:223], v[244:247]
    v_cvt_pk_bf16_f32 v28, v232, v233
    v_cvt_pk_bf16_f32 v29, v234, v235
    global_store_dwordx2 v17, v[28:29], s[28:29] offset:32
    v_cvt_pk_bf16_f32 v30, v236, v237
    v_cvt_pk_bf16_f32 v31, v238, v239
    global_store_dwordx2 v18, v[30:31], s[28:29] offset:32
    v_mfma_f32_16x16x32_bf16 v[248:251], v[76:79], v[192:195], 0
    v_mfma_f32_16x16x32_bf16 v[252:255], v[76:79], v[196:199], 0
    v_mfma_f32_16x16x32_bf16 v[248:251], v[108:111], v[200:203], v[248:251]
    v_mfma_f32_16x16x32_bf16 v[252:255], v[108:111], v[204:207], v[252:255]
    v_mfma_f32_16x16x32_bf16 v[248:251], v[140:143], v[208:211], v[248:251]
    v_mfma_f32_16x16x32_bf16 v[252:255], v[140:143], v[212:215], v[252:255]
    v_mfma_f32_16x16x32_bf16 v[248:251], v[172:175], v[216:219], v[248:251]
    v_mfma_f32_16x16x32_bf16 v[252:255], v[172:175], v[220:223], v[252:255]
    v_cvt_pk_bf16_f32 v24, v240, v241
    v_cvt_pk_bf16_f32 v25, v242, v243
    global_store_dwordx2 v17, v[24:25], s[28:29] offset:64
    v_cvt_pk_bf16_f32 v26, v244, v245
    v_cvt_pk_bf16_f32 v27, v246, v247
    global_store_dwordx2 v18, v[26:27], s[28:29] offset:64
    v_mfma_f32_16x16x32_bf16 v[32:35], v[80:83], v[192:195], 0
    v_mfma_f32_16x16x32_bf16 v[36:39], v[80:83], v[196:199], 0
    v_mfma_f32_16x16x32_bf16 v[32:35], v[112:115], v[200:203], v[32:35]
    v_mfma_f32_16x16x32_bf16 v[36:39], v[112:115], v[204:207], v[36:39]
    v_mfma_f32_16x16x32_bf16 v[32:35], v[144:147], v[208:211], v[32:35]
    v_mfma_f32_16x16x32_bf16 v[36:39], v[144:147], v[212:215], v[36:39]
    v_mfma_f32_16x16x32_bf16 v[32:35], v[176:179], v[216:219], v[32:35]
    v_mfma_f32_16x16x32_bf16 v[36:39], v[176:179], v[220:223], v[36:39]
    v_cvt_pk_bf16_f32 v28, v248, v249
    v_cvt_pk_bf16_f32 v29, v250, v251
    global_store_dwordx2 v17, v[28:29], s[28:29] offset:96
    v_cvt_pk_bf16_f32 v30, v252, v253
    v_cvt_pk_bf16_f32 v31, v254, v255
    global_store_dwordx2 v18, v[30:31], s[28:29] offset:96
    v_mfma_f32_16x16x32_bf16 v[40:43], v[84:87], v[192:195], 0
    v_mfma_f32_16x16x32_bf16 v[44:47], v[84:87], v[196:199], 0
    v_mfma_f32_16x16x32_bf16 v[40:43], v[116:119], v[200:203], v[40:43]
    v_mfma_f32_16x16x32_bf16 v[44:47], v[116:119], v[204:207], v[44:47]
    v_mfma_f32_16x16x32_bf16 v[40:43], v[148:151], v[208:211], v[40:43]
    v_mfma_f32_16x16x32_bf16 v[44:47], v[148:151], v[212:215], v[44:47]
    v_mfma_f32_16x16x32_bf16 v[40:43], v[180:183], v[216:219], v[40:43]
    v_mfma_f32_16x16x32_bf16 v[44:47], v[180:183], v[220:223], v[44:47]
    v_cvt_pk_bf16_f32 v24, v32, v33
    v_cvt_pk_bf16_f32 v25, v34, v35
    global_store_dwordx2 v17, v[24:25], s[28:29] offset:128
    v_cvt_pk_bf16_f32 v26, v36, v37
    v_cvt_pk_bf16_f32 v27, v38, v39
    global_store_dwordx2 v18, v[26:27], s[28:29] offset:128
    v_mfma_f32_16x16x32_bf16 v[48:51], v[88:91], v[192:195], 0
    v_mfma_f32_16x16x32_bf16 v[52:55], v[88:91], v[196:199], 0
    v_mfma_f32_16x16x32_bf16 v[48:51], v[120:123], v[200:203], v[48:51]
    v_mfma_f32_16x16x32_bf16 v[52:55], v[120:123], v[204:207], v[52:55]
    v_mfma_f32_16x16x32_bf16 v[48:51], v[152:155], v[208:211], v[48:51]
    v_mfma_f32_16x16x32_bf16 v[52:55], v[152:155], v[212:215], v[52:55]
    v_mfma_f32_16x16x32_bf16 v[48:51], v[184:187], v[216:219], v[48:51]
    v_mfma_f32_16x16x32_bf16 v[52:55], v[184:187], v[220:223], v[52:55]
    v_cvt_pk_bf16_f32 v28, v40, v41
    v_cvt_pk_bf16_f32 v29, v42, v43
    global_store_dwordx2 v17, v[28:29], s[28:29] offset:160
    v_cvt_pk_bf16_f32 v30, v44, v45
    v_cvt_pk_bf16_f32 v31, v46, v47
    global_store_dwordx2 v18, v[30:31], s[28:29] offset:160
    v_mfma_f32_16x16x32_bf16 v[56:59], v[92:95], v[192:195], 0
    v_mfma_f32_16x16x32_bf16 v[60:63], v[92:95], v[196:199], 0
    v_mfma_f32_16x16x32_bf16 v[56:59], v[124:127], v[200:203], v[56:59]
    v_mfma_f32_16x16x32_bf16 v[60:63], v[124:127], v[204:207], v[60:63]
    v_mfma_f32_16x16x32_bf16 v[56:59], v[156:159], v[208:211], v[56:59]
    v_mfma_f32_16x16x32_bf16 v[60:63], v[156:159], v[212:215], v[60:63]
    v_mfma_f32_16x16x32_bf16 v[56:59], v[188:191], v[216:219], v[56:59]
    v_mfma_f32_16x16x32_bf16 v[60:63], v[188:191], v[220:223], v[60:63]
    v_cvt_pk_bf16_f32 v24, v48, v49
    v_cvt_pk_bf16_f32 v25, v50, v51
    global_store_dwordx2 v17, v[24:25], s[28:29] offset:192
    v_cvt_pk_bf16_f32 v26, v52, v53
    v_cvt_pk_bf16_f32 v27, v54, v55
    global_store_dwordx2 v18, v[26:27], s[28:29] offset:192
    s_nop 7
    s_nop 7
    v_cvt_pk_bf16_f32 v28, v56, v57
    v_cvt_pk_bf16_f32 v29, v58, v59
    global_store_dwordx2 v17, v[28:29], s[28:29] offset:224
    v_cvt_pk_bf16_f32 v30, v60, v61
    v_cvt_pk_bf16_f32 v31, v62, v63
    global_store_dwordx2 v18, v[30:31], s[28:29] offset:224
    s_branch K2_END
K2_A:
    v_mov_b32 v16, 0
    v_mov_b32 v17, 0
    v_mov_b32 v18, 0
    v_mov_b32 v19, 0
    v_mov_b32 v20, 0
    v_mov_b32 v21, 0
    v_mov_b32 v22, 0
    v_mov_b32 v23, 0
    v_mov_b32 v24, 0
    v_mov_b32 v25, 0
    v_mov_b32 v26, 0
    v_mov_b32 v27, 0
    v_mov_b32 v28, 0
    v_mov_b32 v29, 0
    v_mov_b32 v30, 0
    v_mov_b32 v31, 0
    s_lshl_b32 s26, s24, 10
    v_lshlrev_b32 v10, 8, v8
    v_lshlrev_b32 v11, 4, v9
    v_add_u32 v10, v10, v11
    v_add_u32 v11, s26, v10
    v_cmp_gt_u32 vcc, 4, v8
    s_nop 1
    s_and_saveexec_b64 s[16:17], vcc
    global_load_dwordx4 v[16:19], v11, s[4:5] offset:0
    global_load_dwordx4 v[20:23], v11, s[4:5] offset:64
    global_load_dwordx4 v[24:27], v11, s[4:5] offset:128
    global_load_dwordx4 v[28:31], v11, s[4:5] offset:192
    s_mov_b64 exec, s[16:17]
    s_mul_i32 s26, s22, 18432
    s_add_u32 s26, s26, 12288
    v_mul_u32_u24 v14, 288, v9
    v_lshlrev_b32 v15, 4, v8
    v_add3_u32 v14, v14, v15, s26
    v_lshrrev_b32 v15, 2, v8
    v_lshl_add_u32 v15, v9, 2, v15
    v_mul_u32_u24 v15, 288, v15
    v_and_b32 v13, 3, v6
    v_lshlrev_b32 v13, 3, v13
    v_add3_u32 v15, v15, v13, s26
    s_waitcnt vmcnt(0)
    v_mfma_f32_16x16x32_bf16 v[32:35], a[0:3], v[16:19], 0
    v_mfma_f32_16x16x32_bf16 v[36:39], a[16:19], v[16:19], 0
    v_mfma_f32_16x16x32_bf16 v[40:43], a[32:35], v[16:19], 0
    v_mfma_f32_16x16x32_bf16 v[44:47], a[48:51], v[16:19], 0
    v_mfma_f32_16x16x32_bf16 v[32:35], a[4:7], v[20:23], v[32:35]
    v_mfma_f32_16x16x32_bf16 v[36:39], a[20:23], v[20:23], v[36:39]
    v_mfma_f32_16x16x32_bf16 v[40:43], a[36:39], v[20:23], v[40:43]
    v_mfma_f32_16x16x32_bf16 v[44:47], a[52:55], v[20:23], v[44:47]
    v_mfma_f32_16x16x32_bf16 v[32:35], a[8:11], v[24:27], v[32:35]
    v_mfma_f32_16x16x32_bf16 v[36:39], a[24:27], v[24:27], v[36:39]
    v_mfma_f32_16x16x32_bf16 v[40:43], a[40:43], v[24:27], v[40:43]
    v_mfma_f32_16x16x32_bf16 v[44:47], a[56:59], v[24:27], v[44:47]
    v_mfma_f32_16x16x32_bf16 v[32:35], a[12:15], v[28:31], v[32:35]
    v_mfma_f32_16x16x32_bf16 v[36:39], a[28:31], v[28:31], v[36:39]
    v_mfma_f32_16x16x32_bf16 v[40:43], a[44:47], v[28:31], v[40:43]
    v_mfma_f32_16x16x32_bf16 v[44:47], a[60:63], v[28:31], v[44:47]
    s_waitcnt vmcnt(0)
    ds_write_b128 v14, a[64:67] offset:0
    ds_write_b128 v14, a[68:71] offset:1152
    ds_write_b128 v14, a[72:75] offset:2304
    ds_write_b128 v14, a[76:79] offset:3456
    ds_write_b128 v14, a[80:83] offset:4608
    ds_write_b128 v14, a[84:87] offset:5760
    ds_write_b128 v14, a[88:91] offset:6912
    ds_write_b128 v14, a[92:95] offset:8064
    ds_write_b128 v14, a[96:99] offset:9216
    ds_write_b128 v14, a[100:103] offset:10368
    ds_write_b128 v14, a[104:107] offset:11520
    ds_write_b128 v14, a[108:111] offset:12672
    ds_write_b128 v14, a[112:115] offset:13824
    ds_write_b128 v14, a[116:119] offset:14976
    ds_write_b128 v14, a[120:123] offset:16128
    ds_write_b128 v14, a[124:127] offset:17280
    s_nop 7
    v_cvt_pk_bf16_f32 v18, v32, v33
    v_lshlrev_b32 v32, 16, v18
    v_and_b32 v33, 0xffff0000, v18
    v_mul_f32 v32, s20, v32
    v_mul_f32 v33, s20, v33
    v_cvt_pk_bf16_f32 v18, v32, v33
    v_lshlrev_b32 v32, 16, v18
    v_and_b32 v33, 0xffff0000, v18
    v_cvt_pk_bf16_f32 v18, v34, v35
    v_lshlrev_b32 v34, 16, v18
    v_and_b32 v35, 0xffff0000, v18
    v_mul_f32 v34, s20, v34
    v_mul_f32 v35, s20, v35
    v_cvt_pk_bf16_f32 v18, v34, v35
    v_lshlrev_b32 v34, 16, v18
    v_and_b32 v35, 0xffff0000, v18
    v_cvt_pk_bf16_f32 v18, v36, v37
    v_lshlrev_b32 v36, 16, v18
    v_and_b32 v37, 0xffff0000, v18
    v_mul_f32 v36, s20, v36
    v_mul_f32 v37, s20, v37
    v_cvt_pk_bf16_f32 v18, v36, v37
    v_lshlrev_b32 v36, 16, v18
    v_and_b32 v37, 0xffff0000, v18
    v_cvt_pk_bf16_f32 v18, v38, v39
    v_lshlrev_b32 v38, 16, v18
    v_and_b32 v39, 0xffff0000, v18
    v_mul_f32 v38, s20, v38
    v_mul_f32 v39, s20, v39
    v_cvt_pk_bf16_f32 v18, v38, v39
    v_lshlrev_b32 v38, 16, v18
    v_and_b32 v39, 0xffff0000, v18
    v_cvt_pk_bf16_f32 v18, v40, v41
    v_lshlrev_b32 v40, 16, v18
    v_and_b32 v41, 0xffff0000, v18
    v_mul_f32 v40, s20, v40
    v_mul_f32 v41, s20, v41
    v_cvt_pk_bf16_f32 v18, v40, v41
    v_lshlrev_b32 v40, 16, v18
    v_and_b32 v41, 0xffff0000, v18
    v_cvt_pk_bf16_f32 v18, v42, v43
    v_lshlrev_b32 v42, 16, v18
    v_and_b32 v43, 0xffff0000, v18
    v_mul_f32 v42, s20, v42
    v_mul_f32 v43, s20, v43
    v_cvt_pk_bf16_f32 v18, v42, v43
    v_lshlrev_b32 v42, 16, v18
    v_and_b32 v43, 0xffff0000, v18
    v_cvt_pk_bf16_f32 v18, v44, v45
    v_lshlrev_b32 v44, 16, v18
    v_and_b32 v45, 0xffff0000, v18
    v_mul_f32 v44, s20, v44
    v_mul_f32 v45, s20, v45
    v_cvt_pk_bf16_f32 v18, v44, v45
    v_lshlrev_b32 v44, 16, v18
    v_and_b32 v45, 0xffff0000, v18
    v_cvt_pk_bf16_f32 v18, v46, v47
    v_lshlrev_b32 v46, 16, v18
    v_and_b32 v47, 0xffff0000, v18
    v_mul_f32 v46, s20, v46
    v_mul_f32 v47, s20, v47
    v_cvt_pk_bf16_f32 v18, v46, v47
    v_lshlrev_b32 v46, 16, v18
    v_and_b32 v47, 0xffff0000, v18
    v_max3_f32 v20, v32, v33, v34
    v_max3_f32 v20, v20, v35, v36
    v_max3_f32 v20, v20, v37, v38
    v_max3_f32 v20, v20, v39, v40
    v_max3_f32 v20, v20, v41, v42
    v_max3_f32 v20, v20, v43, v44
    v_max3_f32 v20, v20, v45, v46
    v_max_f32 v20, v20, v47
    v_xor_b32 v21, 16, v6
    v_lshlrev_b32 v21, 2, v21
    v_xor_b32 v22, 32, v6
    v_lshlrev_b32 v22, 2, v22
    s_waitcnt lgkmcnt(0)
    ds_bpermute_b32 v23, v21, v20
    s_waitcnt lgkmcnt(0)
    v_max_f32 v20, v20, v23
    ds_bpermute_b32 v23, v22, v20
    s_waitcnt lgkmcnt(0)
    v_max_f32 v20, v20, v23
    v_sub_f32 v32, v32, v20
    v_mul_f32 v32, s21, v32
    v_exp_f32 v32, v32
    v_sub_f32 v33, v33, v20
    v_mul_f32 v33, s21, v33
    v_exp_f32 v33, v33
    v_sub_f32 v34, v34, v20
    v_mul_f32 v34, s21, v34
    v_exp_f32 v34, v34
    v_sub_f32 v35, v35, v20
    v_mul_f32 v35, s21, v35
    v_exp_f32 v35, v35
    v_sub_f32 v36, v36, v20
    v_mul_f32 v36, s21, v36
    v_exp_f32 v36, v36
    v_sub_f32 v37, v37, v20
    v_mul_f32 v37, s21, v37
    v_exp_f32 v37, v37
    v_sub_f32 v38, v38, v20
    v_mul_f32 v38, s21, v38
    v_exp_f32 v38, v38
    v_sub_f32 v39, v39, v20
    v_mul_f32 v39, s21, v39
    v_exp_f32 v39, v39
    v_sub_f32 v40, v40, v20
    v_mul_f32 v40, s21, v40
    v_exp_f32 v40, v40
    v_sub_f32 v41, v41, v20
    v_mul_f32 v41, s21, v41
    v_exp_f32 v41, v41
    v_sub_f32 v42, v42, v20
    v_mul_f32 v42, s21, v42
    v_exp_f32 v42, v42
    v_sub_f32 v43, v43, v20
    v_mul_f32 v43, s21, v43
    v_exp_f32 v43, v43
    v_sub_f32 v44, v44, v20
    v_mul_f32 v44, s21, v44
    v_exp_f32 v44, v44
    v_sub_f32 v45, v45, v20
    v_mul_f32 v45, s21, v45
    v_exp_f32 v45, v45
    v_sub_f32 v46, v46, v20
    v_mul_f32 v46, s21, v46
    v_exp_f32 v46, v46
    v_sub_f32 v47, v47, v20
    v_mul_f32 v47, s21, v47
    v_exp_f32 v47, v47
    s_nop 1
    v_add_f32 v24, v32, v33
    v_add_f32 v24, v24, v34
    v_add_f32 v24, v24, v35
    v_add_f32 v24, v24, v36
    v_add_f32 v24, v24, v37
    v_add_f32 v24, v24, v38
    v_add_f32 v24, v24, v39
    v_add_f32 v24, v24, v40
    v_add_f32 v24, v24, v41
    v_add_f32 v24, v24, v42
    v_add_f32 v24, v24, v43
    v_add_f32 v24, v24, v44
    v_add_f32 v24, v24, v45
    v_add_f32 v24, v24, v46
    v_add_f32 v24, v24, v47
    ds_bpermute_b32 v23, v21, v24
    s_waitcnt lgkmcnt(0)
    v_add_f32 v24, v24, v23
    ds_bpermute_b32 v23, v22, v24
    s_waitcnt lgkmcnt(0)
    v_add_f32 v24, v24, v23
    v_cvt_pk_bf16_f32 v48, v32, v33
    v_cvt_pk_bf16_f32 v49, v34, v35
    v_cvt_pk_bf16_f32 v50, v36, v37
    v_cvt_pk_bf16_f32 v51, v38, v39
    v_cvt_pk_bf16_f32 v52, v40, v41
    v_cvt_pk_bf16_f32 v53, v42, v43
    v_cvt_pk_bf16_f32 v54, v44, v45
    v_cvt_pk_bf16_f32 v55, v46, v47
    ds_read_b64_tr_b16 v[64:65], v15 offset:0
    ds_read_b64_tr_b16 v[66:67], v15 offset:4608
    ds_read_b64_tr_b16 v[68:69], v15 offset:32
    ds_read_b64_tr_b16 v[70:71], v15 offset:4640
    ds_read_b64_tr_b16 v[72:73], v15 offset:64
    ds_read_b64_tr_b16 v[74:75], v15 offset:4672
    ds_read_b64_tr_b16 v[76:77], v15 offset:96
    ds_read_b64_tr_b16 v[78:79], v15 offset:4704
    ds_read_b64_tr_b16 v[80:81], v15 offset:128
    ds_read_b64_tr_b16 v[82:83], v15 offset:4736
    ds_read_b64_tr_b16 v[84:85], v15 offset:160
    ds_read_b64_tr_b16 v[86:87], v15 offset:4768
    ds_read_b64_tr_b16 v[88:89], v15 offset:192
    ds_read_b64_tr_b16 v[90:91], v15 offset:4800
    ds_read_b64_tr_b16 v[92:93], v15 offset:224
    ds_read_b64_tr_b16 v[94:95], v15 offset:4832
    ds_read_b64_tr_b16 v[96:97], v15 offset:9216
    ds_read_b64_tr_b16 v[98:99], v15 offset:13824
    ds_read_b64_tr_b16 v[100:101], v15 offset:9248
    ds_read_b64_tr_b16 v[102:103], v15 offset:13856
    ds_read_b64_tr_b16 v[104:105], v15 offset:9280
    ds_read_b64_tr_b16 v[106:107], v15 offset:13888
    ds_read_b64_tr_b16 v[108:109], v15 offset:9312
    ds_read_b64_tr_b16 v[110:111], v15 offset:13920
    ds_read_b64_tr_b16 v[112:113], v15 offset:9344
    ds_read_b64_tr_b16 v[114:115], v15 offset:13952
    ds_read_b64_tr_b16 v[116:117], v15 offset:9376
    ds_read_b64_tr_b16 v[118:119], v15 offset:13984
    ds_read_b64_tr_b16 v[120:121], v15 offset:9408
    ds_read_b64_tr_b16 v[122:123], v15 offset:14016
    ds_read_b64_tr_b16 v[124:125], v15 offset:9440
    ds_read_b64_tr_b16 v[126:127], v15 offset:14048
    s_waitcnt lgkmcnt(0)
    v_mfma_f32_16x16x32_bf16 v[192:195], v[64:67], v[48:51], 0
    v_mfma_f32_16x16x32_bf16 v[196:199], v[68:71], v[48:51], 0
    v_mfma_f32_16x16x32_bf16 v[200:203], v[72:75], v[48:51], 0
    v_mfma_f32_16x16x32_bf16 v[204:207], v[76:79], v[48:51], 0
    v_mfma_f32_16x16x32_bf16 v[208:211], v[80:83], v[48:51], 0
    v_mfma_f32_16x16x32_bf16 v[212:215], v[84:87], v[48:51], 0
    v_mfma_f32_16x16x32_bf16 v[216:219], v[88:91], v[48:51], 0
    v_mfma_f32_16x16x32_bf16 v[220:223], v[92:95], v[48:51], 0
    v_mfma_f32_16x16x32_bf16 v[192:195], v[96:99], v[52:55], v[192:195]
    v_mfma_f32_16x16x32_bf16 v[196:199], v[100:103], v[52:55], v[196:199]
    v_mfma_f32_16x16x32_bf16 v[200:203], v[104:107], v[52:55], v[200:203]
    v_mfma_f32_16x16x32_bf16 v[204:207], v[108:111], v[52:55], v[204:207]
    v_mfma_f32_16x16x32_bf16 v[208:211], v[112:115], v[52:55], v[208:211]
    v_mfma_f32_16x16x32_bf16 v[212:215], v[116:119], v[52:55], v[212:215]
    v_mfma_f32_16x16x32_bf16 v[216:219], v[120:123], v[52:55], v[216:219]
    v_mfma_f32_16x16x32_bf16 v[220:223], v[124:127], v[52:55], v[220:223]
    s_lshl_b32 s26, s24, 5
    s_lshl_b32 s27, s25, 2
    s_add_u32 s26, s26, s27
    s_add_u32 s26, s26, s22
    s_lshl_b32 s27, s26, 11
    s_add_u32 s27, s27, 0x100000
    v_lshlrev_b32 v17, 9, v8
    v_lshlrev_b32 v18, 4, v9
    v_add3_u32 v17, v17, v18, s27
    s_lshl_b32 s28, s26, 5
    s_add_u32 s28, s28, 0x200000
    v_lshlrev_b32 v18, 3, v8
    v_add_u32 v18, s28, v18
    v_mov_b32 v26, v20
    v_mov_b32 v27, v24
    v_cmp_gt_u32 vcc, 4, v8
    v_cmp_gt_u32 s[18:19], 4, v6
    s_nop 7
    s_nop 7
    s_and_saveexec_b64 s[16:17], vcc
    global_store_dwordx4 v17, v[192:195], s[4:5] offset:0
    global_store_dwordx4 v17, v[196:199], s[4:5] offset:64
    global_store_dwordx4 v17, v[200:203], s[4:5] offset:128
    global_store_dwordx4 v17, v[204:207], s[4:5] offset:192
    global_store_dwordx4 v17, v[208:211], s[4:5] offset:256
    global_store_dwordx4 v17, v[212:215], s[4:5] offset:320
    global_store_dwordx4 v17, v[216:219], s[4:5] offset:384
    global_store_dwordx4 v17, v[220:223], s[4:5] offset:448
    s_mov_b64 exec, s[18:19]
    global_store_dwordx2 v18, v[26:27], s[4:5]
    s_mov_b64 exec, s[16:17]
K2_END:
K2_EXIT:
    s_endpgm
.globl k3prj_kernel
.p2align 8
.type k3prj_kernel,@function
k3prj_kernel:
    s_cmp_ge_u32 s2, 256
    s_cbranch_scc1 K3_EXIT
    s_load_dwordx2 s[4:5], s[0:1], 104
    s_mov_b32 s21, 0x3fb8aa3b
    v_and_b32 v6, 63, v0
    v_lshrrev_b32 v7, 6, v0
    s_cmp_ge_u32 s2, 128
    s_cbranch_scc1 K3_A
    s_load_dwordx2 s[6:7], s[0:1], 72
    s_load_dwordx2 s[8:9], s[0:1], 80
    s_and_b32 s12, s2, 31
    s_lshr_b32 s13, s2, 5
    v_lshrrev_b32 v1, 4, v0
    v_and_b32 v2, 15, v0
    s_lshl_b32 s14, s12, 3
    s_add_u32 s14, s14, 0x210000
    v_lshlrev_b32 v3, 8, v0
    v_add_u32 v3, s14, v3
    v_cmp_gt_u32 vcc, 128, v0
    s_waitcnt lgkmcnt(0)
    s_and_saveexec_b64 s[16:17], vcc
    global_load_dwordx2 v[4:5], v3, s[4:5]
    s_mov_b64 exec, s[16:17]
    v_lshrrev_b32 v3, 5, v0
    v_lshlrev_b32 v3, 19, v3
    v_and_b32 v8, 31, v0
    v_lshlrev_b32 v8, 3, v8
    s_lshl_b32 s14, s12, 10
    s_lshl_b32 s15, s13, 8
    s_add_u32 s14, s14, s15
    v_add3_u32 v3, v3, v8, s14
    s_add_u32 s28, s4, 0x400000
    s_addc_u32 s29, s5, 0
    global_load_dwordx2 v[64:65], v3, s[28:29]
    v_add_u32 v3, 0x8000, v3
    global_load_dwordx2 v[66:67], v3, s[28:29]
    v_add_u32 v3, 0x8000, v3
    global_load_dwordx2 v[68:69], v3, s[28:29]
    v_add_u32 v3, 0x8000, v3
    global_load_dwordx2 v[70:71], v3, s[28:29]
    v_add_u32 v3, 0x8000, v3
    global_load_dwordx2 v[72:73], v3, s[28:29]
    v_add_u32 v3, 0x8000, v3
    global_load_dwordx2 v[74:75], v3, s[28:29]
    v_add_u32 v3, 0x8000, v3
    global_load_dwordx2 v[76:77], v3, s[28:29]
    v_add_u32 v3, 0x8000, v3
    global_load_dwordx2 v[78:79], v3, s[28:29]
    v_add_u32 v3, 0x8000, v3
    global_load_dwordx2 v[80:81], v3, s[28:29]
    v_add_u32 v3, 0x8000, v3
    global_load_dwordx2 v[82:83], v3, s[28:29]
    v_add_u32 v3, 0x8000, v3
    global_load_dwordx2 v[84:85], v3, s[28:29]
    v_add_u32 v3, 0x8000, v3
    global_load_dwordx2 v[86:87], v3, s[28:29]
    v_add_u32 v3, 0x8000, v3
    global_load_dwordx2 v[88:89], v3, s[28:29]
    v_add_u32 v3, 0x8000, v3
    global_load_dwordx2 v[90:91], v3, s[28:29]
    v_add_u32 v3, 0x8000, v3
    global_load_dwordx2 v[92:93], v3, s[28:29]
    v_add_u32 v3, 0x8000, v3
    global_load_dwordx2 v[94:95], v3, s[28:29]
    s_waitcnt vmcnt(16)
    v_mov_b32 v9, v4
    s_nop 1
    v_max_f32_dpp v9, v9, v9 row_ror:1 row_mask:0xf bank_mask:0xf
    s_nop 1
    v_max_f32_dpp v9, v9, v9 row_ror:2 row_mask:0xf bank_mask:0xf
    s_nop 1
    v_max_f32_dpp v9, v9, v9 row_ror:4 row_mask:0xf bank_mask:0xf
    s_nop 1
    v_max_f32_dpp v9, v9, v9 row_ror:8 row_mask:0xf bank_mask:0xf
    s_nop 1
    v_readlane_b32 s36, v9, 0
    v_readlane_b32 s37, v9, 16
    v_readlane_b32 s38, v9, 32
    v_readlane_b32 s39, v9, 48
    s_nop 1
    v_mov_b32 v9, s36
    v_max_f32 v9, s37, v9
    v_max_f32 v9, s38, v9
    v_max_f32 v9, s39, v9
    v_sub_f32 v10, v4, v9
    v_mul_f32 v10, s21, v10
    v_exp_f32 v10, v10
    s_nop 1
    v_mul_f32 v11, v10, v5
    s_nop 1
    v_add_f32_dpp v11, v11, v11 row_ror:1 row_mask:0xf bank_mask:0xf
    s_nop 1
    v_add_f32_dpp v11, v11, v11 row_ror:2 row_mask:0xf bank_mask:0xf
    s_nop 1
    v_add_f32_dpp v11, v11, v11 row_ror:4 row_mask:0xf bank_mask:0xf
    s_nop 1
    v_add_f32_dpp v11, v11, v11 row_ror:8 row_mask:0xf bank_mask:0xf
    s_nop 1
    v_readlane_b32 s36, v11, 0
    v_readlane_b32 s37, v11, 16
    v_readlane_b32 s38, v11, 32
    v_readlane_b32 s39, v11, 48
    s_nop 1
    v_mov_b32 v11, s36
    v_add_f32 v11, s37, v11
    v_add_f32 v11, s38, v11
    v_add_f32 v11, s39, v11
    v_rcp_f32 v11, v11
    s_nop 1
    v_mul_f32 v10, v10, v11
    s_lshl_b32 s14, s13, 20
    s_lshl_b32 s15, s12, 8
    s_add_u32 s14, s14, s15
    v_lshlrev_b32 v3, 16, v1
    v_lshlrev_b32 v8, 4, v2
    v_add3_u32 v3, v3, v8, s14
    global_load_dwordx4 v[128:131], v3, s[6:7]
    v_add_u32 v3, 0x2000, v3
    global_load_dwordx4 v[132:135], v3, s[6:7]
    v_add_u32 v3, 0x2000, v3
    global_load_dwordx4 v[136:139], v3, s[6:7]
    v_add_u32 v3, 0x2000, v3
    global_load_dwordx4 v[140:143], v3, s[6:7]
    v_add_u32 v3, 0x2000, v3
    global_load_dwordx4 v[144:147], v3, s[6:7]
    v_add_u32 v3, 0x2000, v3
    global_load_dwordx4 v[148:151], v3, s[6:7]
    v_add_u32 v3, 0x2000, v3
    global_load_dwordx4 v[152:155], v3, s[6:7]
    v_add_u32 v3, 0x2000, v3
    global_load_dwordx4 v[156:159], v3, s[6:7]
    s_lshl_b32 s14, s12, 17
    v_lshlrev_b32 v62, 15, v7
    v_lshlrev_b32 v8, 4, v6
    v_add3_u32 v62, v62, v8, s14
    global_load_dwordx4 v[160:163], v62, s[8:9]
    v_add_u32 v62, 0x400, v62
    global_load_dwordx4 v[164:167], v62, s[8:9]
    v_add_u32 v62, 0x400, v62
    global_load_dwordx4 v[168:171], v62, s[8:9]
    v_add_u32 v62, 0x400, v62
    global_load_dwordx4 v[172:175], v62, s[8:9]
    v_add_u32 v62, 0x400, v62
    global_load_dwordx4 v[176:179], v62, s[8:9]
    v_add_u32 v62, 0x400, v62
    global_load_dwordx4 v[180:183], v62, s[8:9]
    v_add_u32 v62, 0x400, v62
    global_load_dwordx4 v[184:187], v62, s[8:9]
    v_add_u32 v62, 0x400, v62
    global_load_dwordx4 v[188:191], v62, s[8:9]
    v_add_u32 v62, 0x400, v62
    global_load_dwordx4 v[192:195], v62, s[8:9]
    v_add_u32 v62, 0x400, v62
    global_load_dwordx4 v[196:199], v62, s[8:9]
    v_add_u32 v62, 0x400, v62
    global_load_dwordx4 v[200:203], v62, s[8:9]
    v_add_u32 v62, 0x400, v62
    global_load_dwordx4 v[204:207], v62, s[8:9]
    v_add_u32 v62, 0x400, v62
    global_load_dwordx4 v[208:211], v62, s[8:9]
    v_add_u32 v62, 0x400, v62
    global_load_dwordx4 v[212:215], v62, s[8:9]
    v_add_u32 v62, 0x400, v62
    global_load_dwordx4 v[216:219], v62, s[8:9]
    v_add_u32 v62, 0x400, v62
    global_load_dwordx4 v[220:223], v62, s[8:9]
    v_add_u32 v62, 0x400, v62
    global_load_dwordx4 v[224:227], v62, s[8:9]
    v_add_u32 v62, 0x400, v62
    global_load_dwordx4 v[228:231], v62, s[8:9]
    v_add_u32 v62, 0x400, v62
    global_load_dwordx4 v[232:235], v62, s[8:9]
    v_add_u32 v62, 0x400, v62
    global_load_dwordx4 v[236:239], v62, s[8:9]
    v_add_u32 v62, 0x400, v62
    global_load_dwordx4 v[240:243], v62, s[8:9]
    v_add_u32 v62, 0x400, v62
    global_load_dwordx4 v[244:247], v62, s[8:9]
    v_add_u32 v62, 0x400, v62
    global_load_dwordx4 v[248:251], v62, s[8:9]
    v_add_u32 v62, 0x400, v62
    global_load_dwordx4 v[252:255], v62, s[8:9]
    v_add_u32 v62, 0x400, v62
    v_lshlrev_b32 v12, 2, v0
    s_and_saveexec_b64 s[16:17], vcc
    ds_write_b32 v12, v10
    s_mov_b64 exec, s[16:17]
    s_waitcnt lgkmcnt(0)
    s_barrier
    v_lshrrev_b32 v12, 5, v0
    v_lshlrev_b32 v12, 6, v12
    ds_read_b128 v[32:35], v12 offset:0
    ds_read_b128 v[36:39], v12 offset:16
    ds_read_b128 v[40:43], v12 offset:32
    ds_read_b128 v[44:47], v12 offset:48
    s_waitcnt vmcnt(32) lgkmcnt(0)
    v_mov_b32 v16, 0
    v_mov_b32 v17, 0
    v_mov_b32 v18, 0
    v_mov_b32 v19, 0
    v_lshlrev_b32 v48, 16, v64
    v_and_b32 v49, 0xffff0000, v64
    v_lshlrev_b32 v50, 16, v65
    v_and_b32 v51, 0xffff0000, v65
    v_fmac_f32 v16, v48, v32
    v_fmac_f32 v17, v49, v32
    v_fmac_f32 v18, v50, v32
    v_fmac_f32 v19, v51, v32
    v_lshlrev_b32 v48, 16, v66
    v_and_b32 v49, 0xffff0000, v66
    v_lshlrev_b32 v50, 16, v67
    v_and_b32 v51, 0xffff0000, v67
    v_fmac_f32 v16, v48, v33
    v_fmac_f32 v17, v49, v33
    v_fmac_f32 v18, v50, v33
    v_fmac_f32 v19, v51, v33
    v_lshlrev_b32 v48, 16, v68
    v_and_b32 v49, 0xffff0000, v68
    v_lshlrev_b32 v50, 16, v69
    v_and_b32 v51, 0xffff0000, v69
    v_fmac_f32 v16, v48, v34
    v_fmac_f32 v17, v49, v34
    v_fmac_f32 v18, v50, v34
    v_fmac_f32 v19, v51, v34
    v_lshlrev_b32 v48, 16, v70
    v_and_b32 v49, 0xffff0000, v70
    v_lshlrev_b32 v50, 16, v71
    v_and_b32 v51, 0xffff0000, v71
    v_fmac_f32 v16, v48, v35
    v_fmac_f32 v17, v49, v35
    v_fmac_f32 v18, v50, v35
    v_fmac_f32 v19, v51, v35
    v_lshlrev_b32 v48, 16, v72
    v_and_b32 v49, 0xffff0000, v72
    v_lshlrev_b32 v50, 16, v73
    v_and_b32 v51, 0xffff0000, v73
    v_fmac_f32 v16, v48, v36
    v_fmac_f32 v17, v49, v36
    v_fmac_f32 v18, v50, v36
    v_fmac_f32 v19, v51, v36
    v_lshlrev_b32 v48, 16, v74
    v_and_b32 v49, 0xffff0000, v74
    v_lshlrev_b32 v50, 16, v75
    v_and_b32 v51, 0xffff0000, v75
    v_fmac_f32 v16, v48, v37
    v_fmac_f32 v17, v49, v37
    v_fmac_f32 v18, v50, v37
    v_fmac_f32 v19, v51, v37
    v_lshlrev_b32 v48, 16, v76
    v_and_b32 v49, 0xffff0000, v76
    v_lshlrev_b32 v50, 16, v77
    v_and_b32 v51, 0xffff0000, v77
    v_fmac_f32 v16, v48, v38
    v_fmac_f32 v17, v49, v38
    v_fmac_f32 v18, v50, v38
    v_fmac_f32 v19, v51, v38
    v_lshlrev_b32 v48, 16, v78
    v_and_b32 v49, 0xffff0000, v78
    v_lshlrev_b32 v50, 16, v79
    v_and_b32 v51, 0xffff0000, v79
    v_fmac_f32 v16, v48, v39
    v_fmac_f32 v17, v49, v39
    v_fmac_f32 v18, v50, v39
    v_fmac_f32 v19, v51, v39
    v_lshlrev_b32 v48, 16, v80
    v_and_b32 v49, 0xffff0000, v80
    v_lshlrev_b32 v50, 16, v81
    v_and_b32 v51, 0xffff0000, v81
    v_fmac_f32 v16, v48, v40
    v_fmac_f32 v17, v49, v40
    v_fmac_f32 v18, v50, v40
    v_fmac_f32 v19, v51, v40
    v_lshlrev_b32 v48, 16, v82
    v_and_b32 v49, 0xffff0000, v82
    v_lshlrev_b32 v50, 16, v83
    v_and_b32 v51, 0xffff0000, v83
    v_fmac_f32 v16, v48, v41
    v_fmac_f32 v17, v49, v41
    v_fmac_f32 v18, v50, v41
    v_fmac_f32 v19, v51, v41
    v_lshlrev_b32 v48, 16, v84
    v_and_b32 v49, 0xffff0000, v84
    v_lshlrev_b32 v50, 16, v85
    v_and_b32 v51, 0xffff0000, v85
    v_fmac_f32 v16, v48, v42
    v_fmac_f32 v17, v49, v42
    v_fmac_f32 v18, v50, v42
    v_fmac_f32 v19, v51, v42
    v_lshlrev_b32 v48, 16, v86
    v_and_b32 v49, 0xffff0000, v86
    v_lshlrev_b32 v50, 16, v87
    v_and_b32 v51, 0xffff0000, v87
    v_fmac_f32 v16, v48, v43
    v_fmac_f32 v17, v49, v43
    v_fmac_f32 v18, v50, v43
    v_fmac_f32 v19, v51, v43
    v_lshlrev_b32 v48, 16, v88
    v_and_b32 v49, 0xffff0000, v88
    v_lshlrev_b32 v50, 16, v89
    v_and_b32 v51, 0xffff0000, v89
    v_fmac_f32 v16, v48, v44
    v_fmac_f32 v17, v49, v44
    v_fmac_f32 v18, v50, v44
    v_fmac_f32 v19, v51, v44
    v_lshlrev_b32 v48, 16, v90
    v_and_b32 v49, 0xffff0000, v90
    v_lshlrev_b32 v50, 16, v91
    v_and_b32 v51, 0xffff0000, v91
    v_fmac_f32 v16, v48, v45
    v_fmac_f32 v17, v49, v45
    v_fmac_f32 v18, v50, v45
    v_fmac_f32 v19, v51, v45
    v_lshlrev_b32 v48, 16, v92
    v_and_b32 v49, 0xffff0000, v92
    v_lshlrev_b32 v50, 16, v93
    v_and_b32 v51, 0xffff0000, v93
    v_fmac_f32 v16, v48, v46
    v_fmac_f32 v17, v49, v46
    v_fmac_f32 v18, v50, v46
    v_fmac_f32 v19, v51, v46
    v_lshlrev_b32 v48, 16, v94
    v_and_b32 v49, 0xffff0000, v94
    v_lshlrev_b32 v50, 16, v95
    v_and_b32 v51, 0xffff0000, v95
    v_fmac_f32 v16, v48, v47
    v_fmac_f32 v17, v49, v47
    v_fmac_f32 v18, v50, v47
    v_fmac_f32 v19, v51, v47
    v_lshlrev_b32 v12, 4, v0
    ds_write_b128 v12, v[16:19] offset:1024
    s_waitcnt lgkmcnt(0)
    s_barrier
    v_lshrrev_b32 v12, 7, v0
    v_lshlrev_b32 v12, 11, v12
    v_and_b32 v13, 127, v0
    v_lshlrev_b32 v13, 2, v13
    v_add_u32 v12, v12, v13
    ds_read_b32 v32, v12 offset:1024
    ds_read_b32 v33, v12 offset:1536
    ds_read_b32 v34, v12 offset:2048
    ds_read_b32 v35, v12 offset:2560
    s_waitcnt lgkmcnt(0)
    v_add_f32 v32, v32, v33
    v_add_f32 v34, v34, v35
    v_add_f32 v32, v32, v34
    v_lshlrev_b32 v12, 2, v0
    ds_write_b32 v12, v32 offset:8192
    s_waitcnt lgkmcnt(0)
    s_barrier
    v_lshlrev_b32 v12, 5, v1
    ds_read_b128 v[32:35], v12 offset:8192
    ds_read_b128 v[36:39], v12 offset:8208
    ds_read_b128 v[40:43], v12 offset:8704
    ds_read_b128 v[44:47], v12 offset:8720
    v_mov_b32 v16, 0
    v_mov_b32 v17, 0
    v_mov_b32 v18, 0
    v_mov_b32 v19, 0
    v_mov_b32 v20, 0
    v_mov_b32 v21, 0
    v_mov_b32 v22, 0
    v_mov_b32 v23, 0
    v_mov_b32 v24, 0
    v_mov_b32 v25, 0
    v_mov_b32 v26, 0
    v_mov_b32 v27, 0
    v_mov_b32 v28, 0
    v_mov_b32 v29, 0
    v_mov_b32 v30, 0
    v_mov_b32 v31, 0
    s_waitcnt vmcnt(24) lgkmcnt(0)
    v_lshlrev_b32 v48, 16, v128
    v_and_b32 v49, 0xffff0000, v128
    v_lshlrev_b32 v50, 16, v129
    v_and_b32 v51, 0xffff0000, v129
    v_lshlrev_b32 v52, 16, v130
    v_and_b32 v53, 0xffff0000, v130
    v_lshlrev_b32 v54, 16, v131
    v_and_b32 v55, 0xffff0000, v131
    v_fmac_f32 v16, v48, v32
    v_fmac_f32 v24, v48, v40
    v_fmac_f32 v17, v49, v32
    v_fmac_f32 v25, v49, v40
    v_fmac_f32 v18, v50, v32
    v_fmac_f32 v26, v50, v40
    v_fmac_f32 v19, v51, v32
    v_fmac_f32 v27, v51, v40
    v_fmac_f32 v20, v52, v32
    v_fmac_f32 v28, v52, v40
    v_fmac_f32 v21, v53, v32
    v_fmac_f32 v29, v53, v40
    v_fmac_f32 v22, v54, v32
    v_fmac_f32 v30, v54, v40
    v_fmac_f32 v23, v55, v32
    v_fmac_f32 v31, v55, v40
    v_lshlrev_b32 v48, 16, v132
    v_and_b32 v49, 0xffff0000, v132
    v_lshlrev_b32 v50, 16, v133
    v_and_b32 v51, 0xffff0000, v133
    v_lshlrev_b32 v52, 16, v134
    v_and_b32 v53, 0xffff0000, v134
    v_lshlrev_b32 v54, 16, v135
    v_and_b32 v55, 0xffff0000, v135
    v_fmac_f32 v16, v48, v33
    v_fmac_f32 v24, v48, v41
    v_fmac_f32 v17, v49, v33
    v_fmac_f32 v25, v49, v41
    v_fmac_f32 v18, v50, v33
    v_fmac_f32 v26, v50, v41
    v_fmac_f32 v19, v51, v33
    v_fmac_f32 v27, v51, v41
    v_fmac_f32 v20, v52, v33
    v_fmac_f32 v28, v52, v41
    v_fmac_f32 v21, v53, v33
    v_fmac_f32 v29, v53, v41
    v_fmac_f32 v22, v54, v33
    v_fmac_f32 v30, v54, v41
    v_fmac_f32 v23, v55, v33
    v_fmac_f32 v31, v55, v41
    v_lshlrev_b32 v48, 16, v136
    v_and_b32 v49, 0xffff0000, v136
    v_lshlrev_b32 v50, 16, v137
    v_and_b32 v51, 0xffff0000, v137
    v_lshlrev_b32 v52, 16, v138
    v_and_b32 v53, 0xffff0000, v138
    v_lshlrev_b32 v54, 16, v139
    v_and_b32 v55, 0xffff0000, v139
    v_fmac_f32 v16, v48, v34
    v_fmac_f32 v24, v48, v42
    v_fmac_f32 v17, v49, v34
    v_fmac_f32 v25, v49, v42
    v_fmac_f32 v18, v50, v34
    v_fmac_f32 v26, v50, v42
    v_fmac_f32 v19, v51, v34
    v_fmac_f32 v27, v51, v42
    v_fmac_f32 v20, v52, v34
    v_fmac_f32 v28, v52, v42
    v_fmac_f32 v21, v53, v34
    v_fmac_f32 v29, v53, v42
    v_fmac_f32 v22, v54, v34
    v_fmac_f32 v30, v54, v42
    v_fmac_f32 v23, v55, v34
    v_fmac_f32 v31, v55, v42
    v_lshlrev_b32 v48, 16, v140
    v_and_b32 v49, 0xffff0000, v140
    v_lshlrev_b32 v50, 16, v141
    v_and_b32 v51, 0xffff0000, v141
    v_lshlrev_b32 v52, 16, v142
    v_and_b32 v53, 0xffff0000, v142
    v_lshlrev_b32 v54, 16, v143
    v_and_b32 v55, 0xffff0000, v143
    v_fmac_f32 v16, v48, v35
    v_fmac_f32 v24, v48, v43
    v_fmac_f32 v17, v49, v35
    v_fmac_f32 v25, v49, v43
    v_fmac_f32 v18, v50, v35
    v_fmac_f32 v26, v50, v43
    v_fmac_f32 v19, v51, v35
    v_fmac_f32 v27, v51, v43
    v_fmac_f32 v20, v52, v35
    v_fmac_f32 v28, v52, v43
    v_fmac_f32 v21, v53, v35
    v_fmac_f32 v29, v53, v43
    v_fmac_f32 v22, v54, v35
    v_fmac_f32 v30, v54, v43
    v_fmac_f32 v23, v55, v35
    v_fmac_f32 v31, v55, v43
    v_lshlrev_b32 v48, 16, v144
    v_and_b32 v49, 0xffff0000, v144
    v_lshlrev_b32 v50, 16, v145
    v_and_b32 v51, 0xffff0000, v145
    v_lshlrev_b32 v52, 16, v146
    v_and_b32 v53, 0xffff0000, v146
    v_lshlrev_b32 v54, 16, v147
    v_and_b32 v55, 0xffff0000, v147
    v_fmac_f32 v16, v48, v36
    v_fmac_f32 v24, v48, v44
    v_fmac_f32 v17, v49, v36
    v_fmac_f32 v25, v49, v44
    v_fmac_f32 v18, v50, v36
    v_fmac_f32 v26, v50, v44
    v_fmac_f32 v19, v51, v36
    v_fmac_f32 v27, v51, v44
    v_fmac_f32 v20, v52, v36
    v_fmac_f32 v28, v52, v44
    v_fmac_f32 v21, v53, v36
    v_fmac_f32 v29, v53, v44
    v_fmac_f32 v22, v54, v36
    v_fmac_f32 v30, v54, v44
    v_fmac_f32 v23, v55, v36
    v_fmac_f32 v31, v55, v44
    v_lshlrev_b32 v48, 16, v148
    v_and_b32 v49, 0xffff0000, v148
    v_lshlrev_b32 v50, 16, v149
    v_and_b32 v51, 0xffff0000, v149
    v_lshlrev_b32 v52, 16, v150
    v_and_b32 v53, 0xffff0000, v150
    v_lshlrev_b32 v54, 16, v151
    v_and_b32 v55, 0xffff0000, v151
    v_fmac_f32 v16, v48, v37
    v_fmac_f32 v24, v48, v45
    v_fmac_f32 v17, v49, v37
    v_fmac_f32 v25, v49, v45
    v_fmac_f32 v18, v50, v37
    v_fmac_f32 v26, v50, v45
    v_fmac_f32 v19, v51, v37
    v_fmac_f32 v27, v51, v45
    v_fmac_f32 v20, v52, v37
    v_fmac_f32 v28, v52, v45
    v_fmac_f32 v21, v53, v37
    v_fmac_f32 v29, v53, v45
    v_fmac_f32 v22, v54, v37
    v_fmac_f32 v30, v54, v45
    v_fmac_f32 v23, v55, v37
    v_fmac_f32 v31, v55, v45
    v_lshlrev_b32 v48, 16, v152
    v_and_b32 v49, 0xffff0000, v152
    v_lshlrev_b32 v50, 16, v153
    v_and_b32 v51, 0xffff0000, v153
    v_lshlrev_b32 v52, 16, v154
    v_and_b32 v53, 0xffff0000, v154
    v_lshlrev_b32 v54, 16, v155
    v_and_b32 v55, 0xffff0000, v155
    v_fmac_f32 v16, v48, v38
    v_fmac_f32 v24, v48, v46
    v_fmac_f32 v17, v49, v38
    v_fmac_f32 v25, v49, v46
    v_fmac_f32 v18, v50, v38
    v_fmac_f32 v26, v50, v46
    v_fmac_f32 v19, v51, v38
    v_fmac_f32 v27, v51, v46
    v_fmac_f32 v20, v52, v38
    v_fmac_f32 v28, v52, v46
    v_fmac_f32 v21, v53, v38
    v_fmac_f32 v29, v53, v46
    v_fmac_f32 v22, v54, v38
    v_fmac_f32 v30, v54, v46
    v_fmac_f32 v23, v55, v38
    v_fmac_f32 v31, v55, v46
    v_lshlrev_b32 v48, 16, v156
    v_and_b32 v49, 0xffff0000, v156
    v_lshlrev_b32 v50, 16, v157
    v_and_b32 v51, 0xffff0000, v157
    v_lshlrev_b32 v52, 16, v158
    v_and_b32 v53, 0xffff0000, v158
    v_lshlrev_b32 v54, 16, v159
    v_and_b32 v55, 0xffff0000, v159
    v_fmac_f32 v16, v48, v39
    v_fmac_f32 v24, v48, v47
    v_fmac_f32 v17, v49, v39
    v_fmac_f32 v25, v49, v47
    v_fmac_f32 v18, v50, v39
    v_fmac_f32 v26, v50, v47
    v_fmac_f32 v19, v51, v39
    v_fmac_f32 v27, v51, v47
    v_fmac_f32 v20, v52, v39
    v_fmac_f32 v28, v52, v47
    v_fmac_f32 v21, v53, v39
    v_fmac_f32 v29, v53, v47
    v_fmac_f32 v22, v54, v39
    v_fmac_f32 v30, v54, v47
    v_fmac_f32 v23, v55, v39
    v_fmac_f32 v31, v55, v47
    v_lshlrev_b32 v12, 10, v1
    v_lshlrev_b32 v13, 5, v2
    v_add_u32 v12, v12, v13
    ds_write_b128 v12, v[16:19] offset:16384
    ds_write_b128 v12, v[20:23] offset:16400
    ds_write_b128 v12, v[24:27] offset:16896
    ds_write_b128 v12, v[28:31] offset:16912
    global_load_dwordx4 v[64:67], v62, s[8:9]
    v_add_u32 v62, 0x400, v62
    global_load_dwordx4 v[68:71], v62, s[8:9]
    v_add_u32 v62, 0x400, v62
    global_load_dwordx4 v[72:75], v62, s[8:9]
    v_add_u32 v62, 0x400, v62
    global_load_dwordx4 v[76:79], v62, s[8:9]
    v_add_u32 v62, 0x400, v62
    global_load_dwordx4 v[80:83], v62, s[8:9]
    v_add_u32 v62, 0x400, v62
    global_load_dwordx4 v[84:87], v62, s[8:9]
    v_add_u32 v62, 0x400, v62
    global_load_dwordx4 v[88:91], v62, s[8:9]
    v_add_u32 v62, 0x400, v62
    global_load_dwordx4 v[92:95], v62, s[8:9]
    s_waitcnt lgkmcnt(0)
    s_barrier
    v_lshlrev_b32 v12, 2, v0
    ds_read_b32 v32, v12 offset:16384
    ds_read_b32 v33, v12 offset:17408
    ds_read_b32 v34, v12 offset:18432
    ds_read_b32 v35, v12 offset:19456
    ds_read_b32 v36, v12 offset:20480
    ds_read_b32 v37, v12 offset:21504
    ds_read_b32 v38, v12 offset:22528
    ds_read_b32 v39, v12 offset:23552
    ds_read_b32 v40, v12 offset:24576
    ds_read_b32 v41, v12 offset:25600
    ds_read_b32 v42, v12 offset:26624
    ds_read_b32 v43, v12 offset:27648
    ds_read_b32 v44, v12 offset:28672
    ds_read_b32 v45, v12 offset:29696
    ds_read_b32 v46, v12 offset:30720
    ds_read_b32 v47, v12 offset:31744
    s_waitcnt lgkmcnt(0)
    v_add_f32 v32, v32, v33
    v_add_f32 v32, v32, v34
    v_add_f32 v32, v32, v35
    v_add_f32 v32, v32, v36
    v_add_f32 v32, v32, v37
    v_add_f32 v32, v32, v38
    v_add_f32 v32, v32, v39
    v_add_f32 v32, v32, v40
    v_add_f32 v32, v32, v41
    v_add_f32 v32, v32, v42
    v_add_f32 v32, v32, v43
    v_add_f32 v32, v32, v44
    v_add_f32 v32, v32, v45
    v_add_f32 v32, v32, v46
    v_add_f32 v32, v32, v47
    ds_write_b32 v12, v32 offset:32768
    s_waitcnt lgkmcnt(0)
    s_barrier
    v_lshlrev_b32 v12, 7, v7
    ds_read_b128 v[96:99], v12 offset:32768
    ds_read_b128 v[100:103], v12 offset:32784
    ds_read_b128 v[104:107], v12 offset:32800
    ds_read_b128 v[108:111], v12 offset:32816
    ds_read_b128 v[112:115], v12 offset:32832
    ds_read_b128 v[116:119], v12 offset:32848
    ds_read_b128 v[120:123], v12 offset:32864
    ds_read_b128 v[124:127], v12 offset:32880
    ds_read_b128 v[128:131], v12 offset:33280
    ds_read_b128 v[132:135], v12 offset:33296
    ds_read_b128 v[136:139], v12 offset:33312
    ds_read_b128 v[140:143], v12 offset:33328
    ds_read_b128 v[144:147], v12 offset:33344
    ds_read_b128 v[148:151], v12 offset:33360
    ds_read_b128 v[152:155], v12 offset:33376
    ds_read_b128 v[156:159], v12 offset:33392
    v_mov_b32 v16, 0
    v_mov_b32 v17, 0
    v_mov_b32 v18, 0
    v_mov_b32 v19, 0
    v_mov_b32 v20, 0
    v_mov_b32 v21, 0
    v_mov_b32 v22, 0
    v_mov_b32 v23, 0
    v_mov_b32 v24, 0
    v_mov_b32 v25, 0
    v_mov_b32 v26, 0
    v_mov_b32 v27, 0
    v_mov_b32 v28, 0
    v_mov_b32 v29, 0
    v_mov_b32 v30, 0
    v_mov_b32 v31, 0
    s_waitcnt vmcnt(0) lgkmcnt(0)
    v_lshlrev_b32 v48, 16, v160
    v_and_b32 v49, 0xffff0000, v160
    v_lshlrev_b32 v50, 16, v161
    v_and_b32 v51, 0xffff0000, v161
    v_lshlrev_b32 v52, 16, v162
    v_and_b32 v53, 0xffff0000, v162
    v_lshlrev_b32 v54, 16, v163
    v_and_b32 v55, 0xffff0000, v163
    v_fmac_f32 v16, v48, v96
    v_fmac_f32 v24, v48, v128
    v_fmac_f32 v17, v49, v96
    v_fmac_f32 v25, v49, v128
    v_fmac_f32 v18, v50, v96
    v_fmac_f32 v26, v50, v128
    v_fmac_f32 v19, v51, v96
    v_fmac_f32 v27, v51, v128
    v_fmac_f32 v20, v52, v96
    v_fmac_f32 v28, v52, v128
    v_fmac_f32 v21, v53, v96
    v_fmac_f32 v29, v53, v128
    v_fmac_f32 v22, v54, v96
    v_fmac_f32 v30, v54, v128
    v_fmac_f32 v23, v55, v96
    v_fmac_f32 v31, v55, v128
    v_lshlrev_b32 v48, 16, v164
    v_and_b32 v49, 0xffff0000, v164
    v_lshlrev_b32 v50, 16, v165
    v_and_b32 v51, 0xffff0000, v165
    v_lshlrev_b32 v52, 16, v166
    v_and_b32 v53, 0xffff0000, v166
    v_lshlrev_b32 v54, 16, v167
    v_and_b32 v55, 0xffff0000, v167
    v_fmac_f32 v16, v48, v97
    v_fmac_f32 v24, v48, v129
    v_fmac_f32 v17, v49, v97
    v_fmac_f32 v25, v49, v129
    v_fmac_f32 v18, v50, v97
    v_fmac_f32 v26, v50, v129
    v_fmac_f32 v19, v51, v97
    v_fmac_f32 v27, v51, v129
    v_fmac_f32 v20, v52, v97
    v_fmac_f32 v28, v52, v129
    v_fmac_f32 v21, v53, v97
    v_fmac_f32 v29, v53, v129
    v_fmac_f32 v22, v54, v97
    v_fmac_f32 v30, v54, v129
    v_fmac_f32 v23, v55, v97
    v_fmac_f32 v31, v55, v129
    v_lshlrev_b32 v48, 16, v168
    v_and_b32 v49, 0xffff0000, v168
    v_lshlrev_b32 v50, 16, v169
    v_and_b32 v51, 0xffff0000, v169
    v_lshlrev_b32 v52, 16, v170
    v_and_b32 v53, 0xffff0000, v170
    v_lshlrev_b32 v54, 16, v171
    v_and_b32 v55, 0xffff0000, v171
    v_fmac_f32 v16, v48, v98
    v_fmac_f32 v24, v48, v130
    v_fmac_f32 v17, v49, v98
    v_fmac_f32 v25, v49, v130
    v_fmac_f32 v18, v50, v98
    v_fmac_f32 v26, v50, v130
    v_fmac_f32 v19, v51, v98
    v_fmac_f32 v27, v51, v130
    v_fmac_f32 v20, v52, v98
    v_fmac_f32 v28, v52, v130
    v_fmac_f32 v21, v53, v98
    v_fmac_f32 v29, v53, v130
    v_fmac_f32 v22, v54, v98
    v_fmac_f32 v30, v54, v130
    v_fmac_f32 v23, v55, v98
    v_fmac_f32 v31, v55, v130
    v_lshlrev_b32 v48, 16, v172
    v_and_b32 v49, 0xffff0000, v172
    v_lshlrev_b32 v50, 16, v173
    v_and_b32 v51, 0xffff0000, v173
    v_lshlrev_b32 v52, 16, v174
    v_and_b32 v53, 0xffff0000, v174
    v_lshlrev_b32 v54, 16, v175
    v_and_b32 v55, 0xffff0000, v175
    v_fmac_f32 v16, v48, v99
    v_fmac_f32 v24, v48, v131
    v_fmac_f32 v17, v49, v99
    v_fmac_f32 v25, v49, v131
    v_fmac_f32 v18, v50, v99
    v_fmac_f32 v26, v50, v131
    v_fmac_f32 v19, v51, v99
    v_fmac_f32 v27, v51, v131
    v_fmac_f32 v20, v52, v99
    v_fmac_f32 v28, v52, v131
    v_fmac_f32 v21, v53, v99
    v_fmac_f32 v29, v53, v131
    v_fmac_f32 v22, v54, v99
    v_fmac_f32 v30, v54, v131
    v_fmac_f32 v23, v55, v99
    v_fmac_f32 v31, v55, v131
    v_lshlrev_b32 v48, 16, v176
    v_and_b32 v49, 0xffff0000, v176
    v_lshlrev_b32 v50, 16, v177
    v_and_b32 v51, 0xffff0000, v177
    v_lshlrev_b32 v52, 16, v178
    v_and_b32 v53, 0xffff0000, v178
    v_lshlrev_b32 v54, 16, v179
    v_and_b32 v55, 0xffff0000, v179
    v_fmac_f32 v16, v48, v100
    v_fmac_f32 v24, v48, v132
    v_fmac_f32 v17, v49, v100
    v_fmac_f32 v25, v49, v132
    v_fmac_f32 v18, v50, v100
    v_fmac_f32 v26, v50, v132
    v_fmac_f32 v19, v51, v100
    v_fmac_f32 v27, v51, v132
    v_fmac_f32 v20, v52, v100
    v_fmac_f32 v28, v52, v132
    v_fmac_f32 v21, v53, v100
    v_fmac_f32 v29, v53, v132
    v_fmac_f32 v22, v54, v100
    v_fmac_f32 v30, v54, v132
    v_fmac_f32 v23, v55, v100
    v_fmac_f32 v31, v55, v132
    v_lshlrev_b32 v48, 16, v180
    v_and_b32 v49, 0xffff0000, v180
    v_lshlrev_b32 v50, 16, v181
    v_and_b32 v51, 0xffff0000, v181
    v_lshlrev_b32 v52, 16, v182
    v_and_b32 v53, 0xffff0000, v182
    v_lshlrev_b32 v54, 16, v183
    v_and_b32 v55, 0xffff0000, v183
    v_fmac_f32 v16, v48, v101
    v_fmac_f32 v24, v48, v133
    v_fmac_f32 v17, v49, v101
    v_fmac_f32 v25, v49, v133
    v_fmac_f32 v18, v50, v101
    v_fmac_f32 v26, v50, v133
    v_fmac_f32 v19, v51, v101
    v_fmac_f32 v27, v51, v133
    v_fmac_f32 v20, v52, v101
    v_fmac_f32 v28, v52, v133
    v_fmac_f32 v21, v53, v101
    v_fmac_f32 v29, v53, v133
    v_fmac_f32 v22, v54, v101
    v_fmac_f32 v30, v54, v133
    v_fmac_f32 v23, v55, v101
    v_fmac_f32 v31, v55, v133
    v_lshlrev_b32 v48, 16, v184
    v_and_b32 v49, 0xffff0000, v184
    v_lshlrev_b32 v50, 16, v185
    v_and_b32 v51, 0xffff0000, v185
    v_lshlrev_b32 v52, 16, v186
    v_and_b32 v53, 0xffff0000, v186
    v_lshlrev_b32 v54, 16, v187
    v_and_b32 v55, 0xffff0000, v187
    v_fmac_f32 v16, v48, v102
    v_fmac_f32 v24, v48, v134
    v_fmac_f32 v17, v49, v102
    v_fmac_f32 v25, v49, v134
    v_fmac_f32 v18, v50, v102
    v_fmac_f32 v26, v50, v134
    v_fmac_f32 v19, v51, v102
    v_fmac_f32 v27, v51, v134
    v_fmac_f32 v20, v52, v102
    v_fmac_f32 v28, v52, v134
    v_fmac_f32 v21, v53, v102
    v_fmac_f32 v29, v53, v134
    v_fmac_f32 v22, v54, v102
    v_fmac_f32 v30, v54, v134
    v_fmac_f32 v23, v55, v102
    v_fmac_f32 v31, v55, v134
    v_lshlrev_b32 v48, 16, v188
    v_and_b32 v49, 0xffff0000, v188
    v_lshlrev_b32 v50, 16, v189
    v_and_b32 v51, 0xffff0000, v189
    v_lshlrev_b32 v52, 16, v190
    v_and_b32 v53, 0xffff0000, v190
    v_lshlrev_b32 v54, 16, v191
    v_and_b32 v55, 0xffff0000, v191
    v_fmac_f32 v16, v48, v103
    v_fmac_f32 v24, v48, v135
    v_fmac_f32 v17, v49, v103
    v_fmac_f32 v25, v49, v135
    v_fmac_f32 v18, v50, v103
    v_fmac_f32 v26, v50, v135
    v_fmac_f32 v19, v51, v103
    v_fmac_f32 v27, v51, v135
    v_fmac_f32 v20, v52, v103
    v_fmac_f32 v28, v52, v135
    v_fmac_f32 v21, v53, v103
    v_fmac_f32 v29, v53, v135
    v_fmac_f32 v22, v54, v103
    v_fmac_f32 v30, v54, v135
    v_fmac_f32 v23, v55, v103
    v_fmac_f32 v31, v55, v135
    v_lshlrev_b32 v48, 16, v192
    v_and_b32 v49, 0xffff0000, v192
    v_lshlrev_b32 v50, 16, v193
    v_and_b32 v51, 0xffff0000, v193
    v_lshlrev_b32 v52, 16, v194
    v_and_b32 v53, 0xffff0000, v194
    v_lshlrev_b32 v54, 16, v195
    v_and_b32 v55, 0xffff0000, v195
    v_fmac_f32 v16, v48, v104
    v_fmac_f32 v24, v48, v136
    v_fmac_f32 v17, v49, v104
    v_fmac_f32 v25, v49, v136
    v_fmac_f32 v18, v50, v104
    v_fmac_f32 v26, v50, v136
    v_fmac_f32 v19, v51, v104
    v_fmac_f32 v27, v51, v136
    v_fmac_f32 v20, v52, v104
    v_fmac_f32 v28, v52, v136
    v_fmac_f32 v21, v53, v104
    v_fmac_f32 v29, v53, v136
    v_fmac_f32 v22, v54, v104
    v_fmac_f32 v30, v54, v136
    v_fmac_f32 v23, v55, v104
    v_fmac_f32 v31, v55, v136
    v_lshlrev_b32 v48, 16, v196
    v_and_b32 v49, 0xffff0000, v196
    v_lshlrev_b32 v50, 16, v197
    v_and_b32 v51, 0xffff0000, v197
    v_lshlrev_b32 v52, 16, v198
    v_and_b32 v53, 0xffff0000, v198
    v_lshlrev_b32 v54, 16, v199
    v_and_b32 v55, 0xffff0000, v199
    v_fmac_f32 v16, v48, v105
    v_fmac_f32 v24, v48, v137
    v_fmac_f32 v17, v49, v105
    v_fmac_f32 v25, v49, v137
    v_fmac_f32 v18, v50, v105
    v_fmac_f32 v26, v50, v137
    v_fmac_f32 v19, v51, v105
    v_fmac_f32 v27, v51, v137
    v_fmac_f32 v20, v52, v105
    v_fmac_f32 v28, v52, v137
    v_fmac_f32 v21, v53, v105
    v_fmac_f32 v29, v53, v137
    v_fmac_f32 v22, v54, v105
    v_fmac_f32 v30, v54, v137
    v_fmac_f32 v23, v55, v105
    v_fmac_f32 v31, v55, v137
    v_lshlrev_b32 v48, 16, v200
    v_and_b32 v49, 0xffff0000, v200
    v_lshlrev_b32 v50, 16, v201
    v_and_b32 v51, 0xffff0000, v201
    v_lshlrev_b32 v52, 16, v202
    v_and_b32 v53, 0xffff0000, v202
    v_lshlrev_b32 v54, 16, v203
    v_and_b32 v55, 0xffff0000, v203
    v_fmac_f32 v16, v48, v106
    v_fmac_f32 v24, v48, v138
    v_fmac_f32 v17, v49, v106
    v_fmac_f32 v25, v49, v138
    v_fmac_f32 v18, v50, v106
    v_fmac_f32 v26, v50, v138
    v_fmac_f32 v19, v51, v106
    v_fmac_f32 v27, v51, v138
    v_fmac_f32 v20, v52, v106
    v_fmac_f32 v28, v52, v138
    v_fmac_f32 v21, v53, v106
    v_fmac_f32 v29, v53, v138
    v_fmac_f32 v22, v54, v106
    v_fmac_f32 v30, v54, v138
    v_fmac_f32 v23, v55, v106
    v_fmac_f32 v31, v55, v138
    v_lshlrev_b32 v48, 16, v204
    v_and_b32 v49, 0xffff0000, v204
    v_lshlrev_b32 v50, 16, v205
    v_and_b32 v51, 0xffff0000, v205
    v_lshlrev_b32 v52, 16, v206
    v_and_b32 v53, 0xffff0000, v206
    v_lshlrev_b32 v54, 16, v207
    v_and_b32 v55, 0xffff0000, v207
    v_fmac_f32 v16, v48, v107
    v_fmac_f32 v24, v48, v139
    v_fmac_f32 v17, v49, v107
    v_fmac_f32 v25, v49, v139
    v_fmac_f32 v18, v50, v107
    v_fmac_f32 v26, v50, v139
    v_fmac_f32 v19, v51, v107
    v_fmac_f32 v27, v51, v139
    v_fmac_f32 v20, v52, v107
    v_fmac_f32 v28, v52, v139
    v_fmac_f32 v21, v53, v107
    v_fmac_f32 v29, v53, v139
    v_fmac_f32 v22, v54, v107
    v_fmac_f32 v30, v54, v139
    v_fmac_f32 v23, v55, v107
    v_fmac_f32 v31, v55, v139
    v_lshlrev_b32 v48, 16, v208
    v_and_b32 v49, 0xffff0000, v208
    v_lshlrev_b32 v50, 16, v209
    v_and_b32 v51, 0xffff0000, v209
    v_lshlrev_b32 v52, 16, v210
    v_and_b32 v53, 0xffff0000, v210
    v_lshlrev_b32 v54, 16, v211
    v_and_b32 v55, 0xffff0000, v211
    v_fmac_f32 v16, v48, v108
    v_fmac_f32 v24, v48, v140
    v_fmac_f32 v17, v49, v108
    v_fmac_f32 v25, v49, v140
    v_fmac_f32 v18, v50, v108
    v_fmac_f32 v26, v50, v140
    v_fmac_f32 v19, v51, v108
    v_fmac_f32 v27, v51, v140
    v_fmac_f32 v20, v52, v108
    v_fmac_f32 v28, v52, v140
    v_fmac_f32 v21, v53, v108
    v_fmac_f32 v29, v53, v140
    v_fmac_f32 v22, v54, v108
    v_fmac_f32 v30, v54, v140
    v_fmac_f32 v23, v55, v108
    v_fmac_f32 v31, v55, v140
    v_lshlrev_b32 v48, 16, v212
    v_and_b32 v49, 0xffff0000, v212
    v_lshlrev_b32 v50, 16, v213
    v_and_b32 v51, 0xffff0000, v213
    v_lshlrev_b32 v52, 16, v214
    v_and_b32 v53, 0xffff0000, v214
    v_lshlrev_b32 v54, 16, v215
    v_and_b32 v55, 0xffff0000, v215
    v_fmac_f32 v16, v48, v109
    v_fmac_f32 v24, v48, v141
    v_fmac_f32 v17, v49, v109
    v_fmac_f32 v25, v49, v141
    v_fmac_f32 v18, v50, v109
    v_fmac_f32 v26, v50, v141
    v_fmac_f32 v19, v51, v109
    v_fmac_f32 v27, v51, v141
    v_fmac_f32 v20, v52, v109
    v_fmac_f32 v28, v52, v141
    v_fmac_f32 v21, v53, v109
    v_fmac_f32 v29, v53, v141
    v_fmac_f32 v22, v54, v109
    v_fmac_f32 v30, v54, v141
    v_fmac_f32 v23, v55, v109
    v_fmac_f32 v31, v55, v141
    v_lshlrev_b32 v48, 16, v216
    v_and_b32 v49, 0xffff0000, v216
    v_lshlrev_b32 v50, 16, v217
    v_and_b32 v51, 0xffff0000, v217
    v_lshlrev_b32 v52, 16, v218
    v_and_b32 v53, 0xffff0000, v218
    v_lshlrev_b32 v54, 16, v219
    v_and_b32 v55, 0xffff0000, v219
    v_fmac_f32 v16, v48, v110
    v_fmac_f32 v24, v48, v142
    v_fmac_f32 v17, v49, v110
    v_fmac_f32 v25, v49, v142
    v_fmac_f32 v18, v50, v110
    v_fmac_f32 v26, v50, v142
    v_fmac_f32 v19, v51, v110
    v_fmac_f32 v27, v51, v142
    v_fmac_f32 v20, v52, v110
    v_fmac_f32 v28, v52, v142
    v_fmac_f32 v21, v53, v110
    v_fmac_f32 v29, v53, v142
    v_fmac_f32 v22, v54, v110
    v_fmac_f32 v30, v54, v142
    v_fmac_f32 v23, v55, v110
    v_fmac_f32 v31, v55, v142
    v_lshlrev_b32 v48, 16, v220
    v_and_b32 v49, 0xffff0000, v220
    v_lshlrev_b32 v50, 16, v221
    v_and_b32 v51, 0xffff0000, v221
    v_lshlrev_b32 v52, 16, v222
    v_and_b32 v53, 0xffff0000, v222
    v_lshlrev_b32 v54, 16, v223
    v_and_b32 v55, 0xffff0000, v223
    v_fmac_f32 v16, v48, v111
    v_fmac_f32 v24, v48, v143
    v_fmac_f32 v17, v49, v111
    v_fmac_f32 v25, v49, v143
    v_fmac_f32 v18, v50, v111
    v_fmac_f32 v26, v50, v143
    v_fmac_f32 v19, v51, v111
    v_fmac_f32 v27, v51, v143
    v_fmac_f32 v20, v52, v111
    v_fmac_f32 v28, v52, v143
    v_fmac_f32 v21, v53, v111
    v_fmac_f32 v29, v53, v143
    v_fmac_f32 v22, v54, v111
    v_fmac_f32 v30, v54, v143
    v_fmac_f32 v23, v55, v111
    v_fmac_f32 v31, v55, v143
    v_lshlrev_b32 v48, 16, v224
    v_and_b32 v49, 0xffff0000, v224
    v_lshlrev_b32 v50, 16, v225
    v_and_b32 v51, 0xffff0000, v225
    v_lshlrev_b32 v52, 16, v226
    v_and_b32 v53, 0xffff0000, v226
    v_lshlrev_b32 v54, 16, v227
    v_and_b32 v55, 0xffff0000, v227
    v_fmac_f32 v16, v48, v112
    v_fmac_f32 v24, v48, v144
    v_fmac_f32 v17, v49, v112
    v_fmac_f32 v25, v49, v144
    v_fmac_f32 v18, v50, v112
    v_fmac_f32 v26, v50, v144
    v_fmac_f32 v19, v51, v112
    v_fmac_f32 v27, v51, v144
    v_fmac_f32 v20, v52, v112
    v_fmac_f32 v28, v52, v144
    v_fmac_f32 v21, v53, v112
    v_fmac_f32 v29, v53, v144
    v_fmac_f32 v22, v54, v112
    v_fmac_f32 v30, v54, v144
    v_fmac_f32 v23, v55, v112
    v_fmac_f32 v31, v55, v144
    v_lshlrev_b32 v48, 16, v228
    v_and_b32 v49, 0xffff0000, v228
    v_lshlrev_b32 v50, 16, v229
    v_and_b32 v51, 0xffff0000, v229
    v_lshlrev_b32 v52, 16, v230
    v_and_b32 v53, 0xffff0000, v230
    v_lshlrev_b32 v54, 16, v231
    v_and_b32 v55, 0xffff0000, v231
    v_fmac_f32 v16, v48, v113
    v_fmac_f32 v24, v48, v145
    v_fmac_f32 v17, v49, v113
    v_fmac_f32 v25, v49, v145
    v_fmac_f32 v18, v50, v113
    v_fmac_f32 v26, v50, v145
    v_fmac_f32 v19, v51, v113
    v_fmac_f32 v27, v51, v145
    v_fmac_f32 v20, v52, v113
    v_fmac_f32 v28, v52, v145
    v_fmac_f32 v21, v53, v113
    v_fmac_f32 v29, v53, v145
    v_fmac_f32 v22, v54, v113
    v_fmac_f32 v30, v54, v145
    v_fmac_f32 v23, v55, v113
    v_fmac_f32 v31, v55, v145
    v_lshlrev_b32 v48, 16, v232
    v_and_b32 v49, 0xffff0000, v232
    v_lshlrev_b32 v50, 16, v233
    v_and_b32 v51, 0xffff0000, v233
    v_lshlrev_b32 v52, 16, v234
    v_and_b32 v53, 0xffff0000, v234
    v_lshlrev_b32 v54, 16, v235
    v_and_b32 v55, 0xffff0000, v235
    v_fmac_f32 v16, v48, v114
    v_fmac_f32 v24, v48, v146
    v_fmac_f32 v17, v49, v114
    v_fmac_f32 v25, v49, v146
    v_fmac_f32 v18, v50, v114
    v_fmac_f32 v26, v50, v146
    v_fmac_f32 v19, v51, v114
    v_fmac_f32 v27, v51, v146
    v_fmac_f32 v20, v52, v114
    v_fmac_f32 v28, v52, v146
    v_fmac_f32 v21, v53, v114
    v_fmac_f32 v29, v53, v146
    v_fmac_f32 v22, v54, v114
    v_fmac_f32 v30, v54, v146
    v_fmac_f32 v23, v55, v114
    v_fmac_f32 v31, v55, v146
    v_lshlrev_b32 v48, 16, v236
    v_and_b32 v49, 0xffff0000, v236
    v_lshlrev_b32 v50, 16, v237
    v_and_b32 v51, 0xffff0000, v237
    v_lshlrev_b32 v52, 16, v238
    v_and_b32 v53, 0xffff0000, v238
    v_lshlrev_b32 v54, 16, v239
    v_and_b32 v55, 0xffff0000, v239
    v_fmac_f32 v16, v48, v115
    v_fmac_f32 v24, v48, v147
    v_fmac_f32 v17, v49, v115
    v_fmac_f32 v25, v49, v147
    v_fmac_f32 v18, v50, v115
    v_fmac_f32 v26, v50, v147
    v_fmac_f32 v19, v51, v115
    v_fmac_f32 v27, v51, v147
    v_fmac_f32 v20, v52, v115
    v_fmac_f32 v28, v52, v147
    v_fmac_f32 v21, v53, v115
    v_fmac_f32 v29, v53, v147
    v_fmac_f32 v22, v54, v115
    v_fmac_f32 v30, v54, v147
    v_fmac_f32 v23, v55, v115
    v_fmac_f32 v31, v55, v147
    v_lshlrev_b32 v48, 16, v240
    v_and_b32 v49, 0xffff0000, v240
    v_lshlrev_b32 v50, 16, v241
    v_and_b32 v51, 0xffff0000, v241
    v_lshlrev_b32 v52, 16, v242
    v_and_b32 v53, 0xffff0000, v242
    v_lshlrev_b32 v54, 16, v243
    v_and_b32 v55, 0xffff0000, v243
    v_fmac_f32 v16, v48, v116
    v_fmac_f32 v24, v48, v148
    v_fmac_f32 v17, v49, v116
    v_fmac_f32 v25, v49, v148
    v_fmac_f32 v18, v50, v116
    v_fmac_f32 v26, v50, v148
    v_fmac_f32 v19, v51, v116
    v_fmac_f32 v27, v51, v148
    v_fmac_f32 v20, v52, v116
    v_fmac_f32 v28, v52, v148
    v_fmac_f32 v21, v53, v116
    v_fmac_f32 v29, v53, v148
    v_fmac_f32 v22, v54, v116
    v_fmac_f32 v30, v54, v148
    v_fmac_f32 v23, v55, v116
    v_fmac_f32 v31, v55, v148
    v_lshlrev_b32 v48, 16, v244
    v_and_b32 v49, 0xffff0000, v244
    v_lshlrev_b32 v50, 16, v245
    v_and_b32 v51, 0xffff0000, v245
    v_lshlrev_b32 v52, 16, v246
    v_and_b32 v53, 0xffff0000, v246
    v_lshlrev_b32 v54, 16, v247
    v_and_b32 v55, 0xffff0000, v247
    v_fmac_f32 v16, v48, v117
    v_fmac_f32 v24, v48, v149
    v_fmac_f32 v17, v49, v117
    v_fmac_f32 v25, v49, v149
    v_fmac_f32 v18, v50, v117
    v_fmac_f32 v26, v50, v149
    v_fmac_f32 v19, v51, v117
    v_fmac_f32 v27, v51, v149
    v_fmac_f32 v20, v52, v117
    v_fmac_f32 v28, v52, v149
    v_fmac_f32 v21, v53, v117
    v_fmac_f32 v29, v53, v149
    v_fmac_f32 v22, v54, v117
    v_fmac_f32 v30, v54, v149
    v_fmac_f32 v23, v55, v117
    v_fmac_f32 v31, v55, v149
    v_lshlrev_b32 v48, 16, v248
    v_and_b32 v49, 0xffff0000, v248
    v_lshlrev_b32 v50, 16, v249
    v_and_b32 v51, 0xffff0000, v249
    v_lshlrev_b32 v52, 16, v250
    v_and_b32 v53, 0xffff0000, v250
    v_lshlrev_b32 v54, 16, v251
    v_and_b32 v55, 0xffff0000, v251
    v_fmac_f32 v16, v48, v118
    v_fmac_f32 v24, v48, v150
    v_fmac_f32 v17, v49, v118
    v_fmac_f32 v25, v49, v150
    v_fmac_f32 v18, v50, v118
    v_fmac_f32 v26, v50, v150
    v_fmac_f32 v19, v51, v118
    v_fmac_f32 v27, v51, v150
    v_fmac_f32 v20, v52, v118
    v_fmac_f32 v28, v52, v150
    v_fmac_f32 v21, v53, v118
    v_fmac_f32 v29, v53, v150
    v_fmac_f32 v22, v54, v118
    v_fmac_f32 v30, v54, v150
    v_fmac_f32 v23, v55, v118
    v_fmac_f32 v31, v55, v150
    v_lshlrev_b32 v48, 16, v252
    v_and_b32 v49, 0xffff0000, v252
    v_lshlrev_b32 v50, 16, v253
    v_and_b32 v51, 0xffff0000, v253
    v_lshlrev_b32 v52, 16, v254
    v_and_b32 v53, 0xffff0000, v254
    v_lshlrev_b32 v54, 16, v255
    v_and_b32 v55, 0xffff0000, v255
    v_fmac_f32 v16, v48, v119
    v_fmac_f32 v24, v48, v151
    v_fmac_f32 v17, v49, v119
    v_fmac_f32 v25, v49, v151
    v_fmac_f32 v18, v50, v119
    v_fmac_f32 v26, v50, v151
    v_fmac_f32 v19, v51, v119
    v_fmac_f32 v27, v51, v151
    v_fmac_f32 v20, v52, v119
    v_fmac_f32 v28, v52, v151
    v_fmac_f32 v21, v53, v119
    v_fmac_f32 v29, v53, v151
    v_fmac_f32 v22, v54, v119
    v_fmac_f32 v30, v54, v151
    v_fmac_f32 v23, v55, v119
    v_fmac_f32 v31, v55, v151
    v_lshlrev_b32 v48, 16, v64
    v_and_b32 v49, 0xffff0000, v64
    v_lshlrev_b32 v50, 16, v65
    v_and_b32 v51, 0xffff0000, v65
    v_lshlrev_b32 v52, 16, v66
    v_and_b32 v53, 0xffff0000, v66
    v_lshlrev_b32 v54, 16, v67
    v_and_b32 v55, 0xffff0000, v67
    v_fmac_f32 v16, v48, v120
    v_fmac_f32 v24, v48, v152
    v_fmac_f32 v17, v49, v120
    v_fmac_f32 v25, v49, v152
    v_fmac_f32 v18, v50, v120
    v_fmac_f32 v26, v50, v152
    v_fmac_f32 v19, v51, v120
    v_fmac_f32 v27, v51, v152
    v_fmac_f32 v20, v52, v120
    v_fmac_f32 v28, v52, v152
    v_fmac_f32 v21, v53, v120
    v_fmac_f32 v29, v53, v152
    v_fmac_f32 v22, v54, v120
    v_fmac_f32 v30, v54, v152
    v_fmac_f32 v23, v55, v120
    v_fmac_f32 v31, v55, v152
    v_lshlrev_b32 v48, 16, v68
    v_and_b32 v49, 0xffff0000, v68
    v_lshlrev_b32 v50, 16, v69
    v_and_b32 v51, 0xffff0000, v69
    v_lshlrev_b32 v52, 16, v70
    v_and_b32 v53, 0xffff0000, v70
    v_lshlrev_b32 v54, 16, v71
    v_and_b32 v55, 0xffff0000, v71
    v_fmac_f32 v16, v48, v121
    v_fmac_f32 v24, v48, v153
    v_fmac_f32 v17, v49, v121
    v_fmac_f32 v25, v49, v153
    v_fmac_f32 v18, v50, v121
    v_fmac_f32 v26, v50, v153
    v_fmac_f32 v19, v51, v121
    v_fmac_f32 v27, v51, v153
    v_fmac_f32 v20, v52, v121
    v_fmac_f32 v28, v52, v153
    v_fmac_f32 v21, v53, v121
    v_fmac_f32 v29, v53, v153
    v_fmac_f32 v22, v54, v121
    v_fmac_f32 v30, v54, v153
    v_fmac_f32 v23, v55, v121
    v_fmac_f32 v31, v55, v153
    v_lshlrev_b32 v48, 16, v72
    v_and_b32 v49, 0xffff0000, v72
    v_lshlrev_b32 v50, 16, v73
    v_and_b32 v51, 0xffff0000, v73
    v_lshlrev_b32 v52, 16, v74
    v_and_b32 v53, 0xffff0000, v74
    v_lshlrev_b32 v54, 16, v75
    v_and_b32 v55, 0xffff0000, v75
    v_fmac_f32 v16, v48, v122
    v_fmac_f32 v24, v48, v154
    v_fmac_f32 v17, v49, v122
    v_fmac_f32 v25, v49, v154
    v_fmac_f32 v18, v50, v122
    v_fmac_f32 v26, v50, v154
    v_fmac_f32 v19, v51, v122
    v_fmac_f32 v27, v51, v154
    v_fmac_f32 v20, v52, v122
    v_fmac_f32 v28, v52, v154
    v_fmac_f32 v21, v53, v122
    v_fmac_f32 v29, v53, v154
    v_fmac_f32 v22, v54, v122
    v_fmac_f32 v30, v54, v154
    v_fmac_f32 v23, v55, v122
    v_fmac_f32 v31, v55, v154
    v_lshlrev_b32 v48, 16, v76
    v_and_b32 v49, 0xffff0000, v76
    v_lshlrev_b32 v50, 16, v77
    v_and_b32 v51, 0xffff0000, v77
    v_lshlrev_b32 v52, 16, v78
    v_and_b32 v53, 0xffff0000, v78
    v_lshlrev_b32 v54, 16, v79
    v_and_b32 v55, 0xffff0000, v79
    v_fmac_f32 v16, v48, v123
    v_fmac_f32 v24, v48, v155
    v_fmac_f32 v17, v49, v123
    v_fmac_f32 v25, v49, v155
    v_fmac_f32 v18, v50, v123
    v_fmac_f32 v26, v50, v155
    v_fmac_f32 v19, v51, v123
    v_fmac_f32 v27, v51, v155
    v_fmac_f32 v20, v52, v123
    v_fmac_f32 v28, v52, v155
    v_fmac_f32 v21, v53, v123
    v_fmac_f32 v29, v53, v155
    v_fmac_f32 v22, v54, v123
    v_fmac_f32 v30, v54, v155
    v_fmac_f32 v23, v55, v123
    v_fmac_f32 v31, v55, v155
    v_lshlrev_b32 v48, 16, v80
    v_and_b32 v49, 0xffff0000, v80
    v_lshlrev_b32 v50, 16, v81
    v_and_b32 v51, 0xffff0000, v81
    v_lshlrev_b32 v52, 16, v82
    v_and_b32 v53, 0xffff0000, v82
    v_lshlrev_b32 v54, 16, v83
    v_and_b32 v55, 0xffff0000, v83
    v_fmac_f32 v16, v48, v124
    v_fmac_f32 v24, v48, v156
    v_fmac_f32 v17, v49, v124
    v_fmac_f32 v25, v49, v156
    v_fmac_f32 v18, v50, v124
    v_fmac_f32 v26, v50, v156
    v_fmac_f32 v19, v51, v124
    v_fmac_f32 v27, v51, v156
    v_fmac_f32 v20, v52, v124
    v_fmac_f32 v28, v52, v156
    v_fmac_f32 v21, v53, v124
    v_fmac_f32 v29, v53, v156
    v_fmac_f32 v22, v54, v124
    v_fmac_f32 v30, v54, v156
    v_fmac_f32 v23, v55, v124
    v_fmac_f32 v31, v55, v156
    v_lshlrev_b32 v48, 16, v84
    v_and_b32 v49, 0xffff0000, v84
    v_lshlrev_b32 v50, 16, v85
    v_and_b32 v51, 0xffff0000, v85
    v_lshlrev_b32 v52, 16, v86
    v_and_b32 v53, 0xffff0000, v86
    v_lshlrev_b32 v54, 16, v87
    v_and_b32 v55, 0xffff0000, v87
    v_fmac_f32 v16, v48, v125
    v_fmac_f32 v24, v48, v157
    v_fmac_f32 v17, v49, v125
    v_fmac_f32 v25, v49, v157
    v_fmac_f32 v18, v50, v125
    v_fmac_f32 v26, v50, v157
    v_fmac_f32 v19, v51, v125
    v_fmac_f32 v27, v51, v157
    v_fmac_f32 v20, v52, v125
    v_fmac_f32 v28, v52, v157
    v_fmac_f32 v21, v53, v125
    v_fmac_f32 v29, v53, v157
    v_fmac_f32 v22, v54, v125
    v_fmac_f32 v30, v54, v157
    v_fmac_f32 v23, v55, v125
    v_fmac_f32 v31, v55, v157
    v_lshlrev_b32 v48, 16, v88
    v_and_b32 v49, 0xffff0000, v88
    v_lshlrev_b32 v50, 16, v89
    v_and_b32 v51, 0xffff0000, v89
    v_lshlrev_b32 v52, 16, v90
    v_and_b32 v53, 0xffff0000, v90
    v_lshlrev_b32 v54, 16, v91
    v_and_b32 v55, 0xffff0000, v91
    v_fmac_f32 v16, v48, v126
    v_fmac_f32 v24, v48, v158
    v_fmac_f32 v17, v49, v126
    v_fmac_f32 v25, v49, v158
    v_fmac_f32 v18, v50, v126
    v_fmac_f32 v26, v50, v158
    v_fmac_f32 v19, v51, v126
    v_fmac_f32 v27, v51, v158
    v_fmac_f32 v20, v52, v126
    v_fmac_f32 v28, v52, v158
    v_fmac_f32 v21, v53, v126
    v_fmac_f32 v29, v53, v158
    v_fmac_f32 v22, v54, v126
    v_fmac_f32 v30, v54, v158
    v_fmac_f32 v23, v55, v126
    v_fmac_f32 v31, v55, v158
    v_lshlrev_b32 v48, 16, v92
    v_and_b32 v49, 0xffff0000, v92
    v_lshlrev_b32 v50, 16, v93
    v_and_b32 v51, 0xffff0000, v93
    v_lshlrev_b32 v52, 16, v94
    v_and_b32 v53, 0xffff0000, v94
    v_lshlrev_b32 v54, 16, v95
    v_and_b32 v55, 0xffff0000, v95
    v_fmac_f32 v16, v48, v127
    v_fmac_f32 v24, v48, v159
    v_fmac_f32 v17, v49, v127
    v_fmac_f32 v25, v49, v159
    v_fmac_f32 v18, v50, v127
    v_fmac_f32 v26, v50, v159
    v_fmac_f32 v19, v51, v127
    v_fmac_f32 v27, v51, v159
    v_fmac_f32 v20, v52, v127
    v_fmac_f32 v28, v52, v159
    v_fmac_f32 v21, v53, v127
    v_fmac_f32 v29, v53, v159
    v_fmac_f32 v22, v54, v127
    v_fmac_f32 v30, v54, v159
    v_fmac_f32 v23, v55, v127
    v_fmac_f32 v31, v55, v159
    s_barrier
    s_add_u32 s15, s2, 128
    v_lshlrev_b32 v12, 12, v7
    v_lshlrev_b32 v13, 5, v6
    v_add_u32 v12, v12, v13
    ds_write_b128 v12, v[16:19]
    ds_write_b128 v12, v[20:23] offset:16
    ds_write_b128 v12, v[24:27] offset:2048
    ds_write_b128 v12, v[28:31] offset:2064
    s_waitcnt lgkmcnt(0)
    s_barrier
    v_lshlrev_b32 v12, 4, v0
    ds_read_b128 v[32:35], v12 offset:0
    ds_read_b128 v[36:39], v12 offset:4096
    ds_read_b128 v[40:43], v12 offset:8192
    ds_read_b128 v[44:47], v12 offset:12288
    s_waitcnt lgkmcnt(0)
    v_add_f32 v32, v32, v36
    v_add_f32 v32, v32, v40
    v_add_f32 v32, v32, v44
    v_add_f32 v33, v33, v37
    v_add_f32 v33, v33, v41
    v_add_f32 v33, v33, v45
    v_add_f32 v34, v34, v38
    v_add_f32 v34, v34, v42
    v_add_f32 v34, v34, v46
    v_add_f32 v35, v35, v39
    v_add_f32 v35, v35, v43
    v_add_f32 v35, v35, v47
    s_lshl_b32 s26, s15, 12
    s_add_u32 s26, s26, 0x1000000
    v_add_u32 v12, s26, v12
    global_store_dwordx4 v12, v[32:35], s[4:5]
    s_branch K3_END
K3_A:
    s_load_dwordx2 s[8:9], s[0:1], 32
    s_sub_u32 s11, s2, 128
    s_and_b32 s12, s11, 31
    s_lshr_b32 s13, s11, 5
    s_lshr_b32 s14, s12, 2
    s_and_b32 s15, s12, 3
    v_lshrrev_b32 v1, 5, v0
    v_and_b32 v2, 31, v0
    v_lshlrev_b32 v3, 8, v1
    v_add_u32 v3, v3, v2
    s_lshl_b32 s18, s14, 5
    v_add_u32 v3, s18, v3
    v_lshlrev_b32 v4, 5, v3
    s_lshl_b32 s19, s15, 3
    s_add_u32 s19, s19, 0x200000
    v_add_u32 v4, s19, v4
    v_cmp_gt_u32 vcc, 64, v0
    s_waitcnt lgkmcnt(0)
    s_and_saveexec_b64 s[16:17], vcc
    global_load_dwordx2 v[4:5], v4, s[4:5]
    s_mov_b64 exec, s[16:17]
    v_lshrrev_b32 v1, 7, v0
    v_bfe_u32 v2, v0, 2, 5
    v_lshlrev_b32 v3, 8, v1
    v_add_u32 v3, v3, v2
    v_add_u32 v3, s18, v3
    v_lshlrev_b32 v3, 11, v3
    v_and_b32 v8, 3, v0
    v_lshlrev_b32 v8, 5, v8
    s_lshl_b32 s19, s15, 9
    s_lshl_b32 s22, s13, 7
    s_add_u32 s19, s19, s22
    s_add_u32 s19, s19, 0x100000
    v_add3_u32 v3, v3, v8, s19
    global_load_dwordx4 v[64:67], v3, s[4:5]
    global_load_dwordx4 v[68:71], v3, s[4:5] offset:16
    s_lshl_b32 s22, s12, 17
    s_lshl_b32 s23, s13, 15
    s_add_u32 s22, s22, s23
    v_lshlrev_b32 v3, 13, v7
    v_lshlrev_b32 v8, 4, v6
    v_add3_u32 v3, v3, v8, s22
    global_load_dwordx4 v[96:99], v3, s[8:9] offset:0
    global_load_dwordx4 v[100:103], v3, s[8:9] offset:1024
    global_load_dwordx4 v[104:107], v3, s[8:9] offset:2048
    global_load_dwordx4 v[108:111], v3, s[8:9] offset:3072
    v_add_u32 v3, 0x1000, v3
    global_load_dwordx4 v[112:115], v3, s[8:9] offset:0
    global_load_dwordx4 v[116:119], v3, s[8:9] offset:1024
    global_load_dwordx4 v[120:123], v3, s[8:9] offset:2048
    global_load_dwordx4 v[124:127], v3, s[8:9] offset:3072
    s_waitcnt vmcnt(10)
    v_xor_b32 v56, 1, v6
    v_lshlrev_b32 v56, 2, v56
    v_xor_b32 v57, 2, v6
    v_lshlrev_b32 v57, 2, v57
    v_xor_b32 v58, 4, v6
    v_lshlrev_b32 v58, 2, v58
    v_xor_b32 v59, 8, v6
    v_lshlrev_b32 v59, 2, v59
    v_xor_b32 v60, 16, v6
    v_lshlrev_b32 v60, 2, v60
    v_mov_b32 v9, v4
    ds_bpermute_b32 v10, v56, v9
    s_waitcnt lgkmcnt(0)
    v_max_f32 v9, v9, v10
    ds_bpermute_b32 v10, v57, v9
    s_waitcnt lgkmcnt(0)
    v_max_f32 v9, v9, v10
    ds_bpermute_b32 v10, v58, v9
    s_waitcnt lgkmcnt(0)
    v_max_f32 v9, v9, v10
    ds_bpermute_b32 v10, v59, v9
    s_waitcnt lgkmcnt(0)
    v_max_f32 v9, v9, v10
    ds_bpermute_b32 v10, v60, v9
    s_waitcnt lgkmcnt(0)
    v_max_f32 v9, v9, v10
    v_sub_f32 v10, v4, v9
    v_mul_f32 v10, s21, v10
    v_exp_f32 v10, v10
    s_nop 1
    v_mul_f32 v11, v10, v5
    ds_bpermute_b32 v12, v56, v11
    s_waitcnt lgkmcnt(0)
    v_add_f32 v11, v11, v12
    ds_bpermute_b32 v12, v57, v11
    s_waitcnt lgkmcnt(0)
    v_add_f32 v11, v11, v12
    ds_bpermute_b32 v12, v58, v11
    s_waitcnt lgkmcnt(0)
    v_add_f32 v11, v11, v12
    ds_bpermute_b32 v12, v59, v11
    s_waitcnt lgkmcnt(0)
    v_add_f32 v11, v11, v12
    ds_bpermute_b32 v12, v60, v11
    s_waitcnt lgkmcnt(0)
    v_add_f32 v11, v11, v12
    v_rcp_f32 v11, v11
    s_nop 1
    v_mul_f32 v10, v10, v11
    v_lshlrev_b32 v12, 2, v0
    s_and_saveexec_b64 s[16:17], vcc
    ds_write_b32 v12, v10
    s_mov_b64 exec, s[16:17]
    s_waitcnt lgkmcnt(0)
    s_barrier
    v_lshrrev_b32 v12, 2, v0
    v_lshlrev_b32 v12, 2, v12
    ds_read_b32 v13, v12
    s_waitcnt vmcnt(8) lgkmcnt(0)
    v_mul_f32 v64, v64, v13
    v_mul_f32 v65, v65, v13
    v_mul_f32 v66, v66, v13
    v_mul_f32 v67, v67, v13
    v_mul_f32 v68, v68, v13
    v_mul_f32 v69, v69, v13
    v_mul_f32 v70, v70, v13
    v_mul_f32 v71, v71, v13
    v_lshlrev_b32 v12, 5, v0
    ds_write_b128 v12, v[64:67] offset:1024
    ds_write_b128 v12, v[68:71] offset:1040
    s_waitcnt lgkmcnt(0)
    s_barrier
    v_lshrrev_b32 v12, 5, v0
    v_lshlrev_b32 v12, 12, v12
    v_and_b32 v13, 31, v0
    v_lshlrev_b32 v13, 2, v13
    v_add_u32 v12, v12, v13
    s_and_saveexec_b64 s[16:17], vcc
    s_cbranch_execz K3A_SKIP
    ds_read_b32 v128, v12 offset:1024
    ds_read_b32 v129, v12 offset:1152
    ds_read_b32 v130, v12 offset:1280
    ds_read_b32 v131, v12 offset:1408
    ds_read_b32 v132, v12 offset:1536
    ds_read_b32 v133, v12 offset:1664
    ds_read_b32 v134, v12 offset:1792
    ds_read_b32 v135, v12 offset:1920
    ds_read_b32 v136, v12 offset:2048
    ds_read_b32 v137, v12 offset:2176
    ds_read_b32 v138, v12 offset:2304
    ds_read_b32 v139, v12 offset:2432
    ds_read_b32 v140, v12 offset:2560
    ds_read_b32 v141, v12 offset:2688
    ds_read_b32 v142, v12 offset:2816
    ds_read_b32 v143, v12 offset:2944
    ds_read_b32 v144, v12 offset:3072
    ds_read_b32 v145, v12 offset:3200
    ds_read_b32 v146, v12 offset:3328
    ds_read_b32 v147, v12 offset:3456
    ds_read_b32 v148, v12 offset:3584
    ds_read_b32 v149, v12 offset:3712
    ds_read_b32 v150, v12 offset:3840
    ds_read_b32 v151, v12 offset:3968
    ds_read_b32 v152, v12 offset:4096
    ds_read_b32 v153, v12 offset:4224
    ds_read_b32 v154, v12 offset:4352
    ds_read_b32 v155, v12 offset:4480
    ds_read_b32 v156, v12 offset:4608
    ds_read_b32 v157, v12 offset:4736
    ds_read_b32 v158, v12 offset:4864
    ds_read_b32 v159, v12 offset:4992
    s_waitcnt lgkmcnt(0)
    v_add_f32 v128, v128, v129
    v_add_f32 v128, v128, v130
    v_add_f32 v128, v128, v131
    v_add_f32 v128, v128, v132
    v_add_f32 v128, v128, v133
    v_add_f32 v128, v128, v134
    v_add_f32 v128, v128, v135
    v_add_f32 v128, v128, v136
    v_add_f32 v128, v128, v137
    v_add_f32 v128, v128, v138
    v_add_f32 v128, v128, v139
    v_add_f32 v128, v128, v140
    v_add_f32 v128, v128, v141
    v_add_f32 v128, v128, v142
    v_add_f32 v128, v128, v143
    v_add_f32 v128, v128, v144
    v_add_f32 v128, v128, v145
    v_add_f32 v128, v128, v146
    v_add_f32 v128, v128, v147
    v_add_f32 v128, v128, v148
    v_add_f32 v128, v128, v149
    v_add_f32 v128, v128, v150
    v_add_f32 v128, v128, v151
    v_add_f32 v128, v128, v152
    v_add_f32 v128, v128, v153
    v_add_f32 v128, v128, v154
    v_add_f32 v128, v128, v155
    v_add_f32 v128, v128, v156
    v_add_f32 v128, v128, v157
    v_add_f32 v128, v128, v158
    v_add_f32 v128, v128, v159
    v_cvt_pk_bf16_f32 v130, v128, v129
    v_lshlrev_b32 v128, 16, v130
    v_and_b32 v129, 0xffff0000, v130
    v_lshlrev_b32 v13, 2, v0
    ds_write_b32 v13, v128 offset:16384
K3A_SKIP:
    s_mov_b64 exec, s[16:17]
    s_waitcnt lgkmcnt(0)
    s_barrier
    v_lshlrev_b32 v12, 5, v7
    ds_read_b128 v[32:35], v12 offset:16384
    ds_read_b128 v[36:39], v12 offset:16400
    ds_read_b128 v[40:43], v12 offset:16512
    ds_read_b128 v[44:47], v12 offset:16528
    v_mov_b32 v16, 0
    v_mov_b32 v17, 0
    v_mov_b32 v18, 0
    v_mov_b32 v19, 0
    v_mov_b32 v20, 0
    v_mov_b32 v21, 0
    v_mov_b32 v22, 0
    v_mov_b32 v23, 0
    v_mov_b32 v24, 0
    v_mov_b32 v25, 0
    v_mov_b32 v26, 0
    v_mov_b32 v27, 0
    v_mov_b32 v28, 0
    v_mov_b32 v29, 0
    v_mov_b32 v30, 0
    v_mov_b32 v31, 0
    s_waitcnt vmcnt(0) lgkmcnt(0)
    v_lshlrev_b32 v48, 16, v96
    v_and_b32 v49, 0xffff0000, v96
    v_lshlrev_b32 v50, 16, v97
    v_and_b32 v51, 0xffff0000, v97
    v_lshlrev_b32 v52, 16, v98
    v_and_b32 v53, 0xffff0000, v98
    v_lshlrev_b32 v54, 16, v99
    v_and_b32 v55, 0xffff0000, v99
    v_fmac_f32 v16, v48, v32
    v_fmac_f32 v24, v48, v40
    v_fmac_f32 v17, v49, v32
    v_fmac_f32 v25, v49, v40
    v_fmac_f32 v18, v50, v32
    v_fmac_f32 v26, v50, v40
    v_fmac_f32 v19, v51, v32
    v_fmac_f32 v27, v51, v40
    v_fmac_f32 v20, v52, v32
    v_fmac_f32 v28, v52, v40
    v_fmac_f32 v21, v53, v32
    v_fmac_f32 v29, v53, v40
    v_fmac_f32 v22, v54, v32
    v_fmac_f32 v30, v54, v40
    v_fmac_f32 v23, v55, v32
    v_fmac_f32 v31, v55, v40
    v_lshlrev_b32 v48, 16, v100
    v_and_b32 v49, 0xffff0000, v100
    v_lshlrev_b32 v50, 16, v101
    v_and_b32 v51, 0xffff0000, v101
    v_lshlrev_b32 v52, 16, v102
    v_and_b32 v53, 0xffff0000, v102
    v_lshlrev_b32 v54, 16, v103
    v_and_b32 v55, 0xffff0000, v103
    v_fmac_f32 v16, v48, v33
    v_fmac_f32 v24, v48, v41
    v_fmac_f32 v17, v49, v33
    v_fmac_f32 v25, v49, v41
    v_fmac_f32 v18, v50, v33
    v_fmac_f32 v26, v50, v41
    v_fmac_f32 v19, v51, v33
    v_fmac_f32 v27, v51, v41
    v_fmac_f32 v20, v52, v33
    v_fmac_f32 v28, v52, v41
    v_fmac_f32 v21, v53, v33
    v_fmac_f32 v29, v53, v41
    v_fmac_f32 v22, v54, v33
    v_fmac_f32 v30, v54, v41
    v_fmac_f32 v23, v55, v33
    v_fmac_f32 v31, v55, v41
    v_lshlrev_b32 v48, 16, v104
    v_and_b32 v49, 0xffff0000, v104
    v_lshlrev_b32 v50, 16, v105
    v_and_b32 v51, 0xffff0000, v105
    v_lshlrev_b32 v52, 16, v106
    v_and_b32 v53, 0xffff0000, v106
    v_lshlrev_b32 v54, 16, v107
    v_and_b32 v55, 0xffff0000, v107
    v_fmac_f32 v16, v48, v34
    v_fmac_f32 v24, v48, v42
    v_fmac_f32 v17, v49, v34
    v_fmac_f32 v25, v49, v42
    v_fmac_f32 v18, v50, v34
    v_fmac_f32 v26, v50, v42
    v_fmac_f32 v19, v51, v34
    v_fmac_f32 v27, v51, v42
    v_fmac_f32 v20, v52, v34
    v_fmac_f32 v28, v52, v42
    v_fmac_f32 v21, v53, v34
    v_fmac_f32 v29, v53, v42
    v_fmac_f32 v22, v54, v34
    v_fmac_f32 v30, v54, v42
    v_fmac_f32 v23, v55, v34
    v_fmac_f32 v31, v55, v42
    v_lshlrev_b32 v48, 16, v108
    v_and_b32 v49, 0xffff0000, v108
    v_lshlrev_b32 v50, 16, v109
    v_and_b32 v51, 0xffff0000, v109
    v_lshlrev_b32 v52, 16, v110
    v_and_b32 v53, 0xffff0000, v110
    v_lshlrev_b32 v54, 16, v111
    v_and_b32 v55, 0xffff0000, v111
    v_fmac_f32 v16, v48, v35
    v_fmac_f32 v24, v48, v43
    v_fmac_f32 v17, v49, v35
    v_fmac_f32 v25, v49, v43
    v_fmac_f32 v18, v50, v35
    v_fmac_f32 v26, v50, v43
    v_fmac_f32 v19, v51, v35
    v_fmac_f32 v27, v51, v43
    v_fmac_f32 v20, v52, v35
    v_fmac_f32 v28, v52, v43
    v_fmac_f32 v21, v53, v35
    v_fmac_f32 v29, v53, v43
    v_fmac_f32 v22, v54, v35
    v_fmac_f32 v30, v54, v43
    v_fmac_f32 v23, v55, v35
    v_fmac_f32 v31, v55, v43
    v_lshlrev_b32 v48, 16, v112
    v_and_b32 v49, 0xffff0000, v112
    v_lshlrev_b32 v50, 16, v113
    v_and_b32 v51, 0xffff0000, v113
    v_lshlrev_b32 v52, 16, v114
    v_and_b32 v53, 0xffff0000, v114
    v_lshlrev_b32 v54, 16, v115
    v_and_b32 v55, 0xffff0000, v115
    v_fmac_f32 v16, v48, v36
    v_fmac_f32 v24, v48, v44
    v_fmac_f32 v17, v49, v36
    v_fmac_f32 v25, v49, v44
    v_fmac_f32 v18, v50, v36
    v_fmac_f32 v26, v50, v44
    v_fmac_f32 v19, v51, v36
    v_fmac_f32 v27, v51, v44
    v_fmac_f32 v20, v52, v36
    v_fmac_f32 v28, v52, v44
    v_fmac_f32 v21, v53, v36
    v_fmac_f32 v29, v53, v44
    v_fmac_f32 v22, v54, v36
    v_fmac_f32 v30, v54, v44
    v_fmac_f32 v23, v55, v36
    v_fmac_f32 v31, v55, v44
    v_lshlrev_b32 v48, 16, v116
    v_and_b32 v49, 0xffff0000, v116
    v_lshlrev_b32 v50, 16, v117
    v_and_b32 v51, 0xffff0000, v117
    v_lshlrev_b32 v52, 16, v118
    v_and_b32 v53, 0xffff0000, v118
    v_lshlrev_b32 v54, 16, v119
    v_and_b32 v55, 0xffff0000, v119
    v_fmac_f32 v16, v48, v37
    v_fmac_f32 v24, v48, v45
    v_fmac_f32 v17, v49, v37
    v_fmac_f32 v25, v49, v45
    v_fmac_f32 v18, v50, v37
    v_fmac_f32 v26, v50, v45
    v_fmac_f32 v19, v51, v37
    v_fmac_f32 v27, v51, v45
    v_fmac_f32 v20, v52, v37
    v_fmac_f32 v28, v52, v45
    v_fmac_f32 v21, v53, v37
    v_fmac_f32 v29, v53, v45
    v_fmac_f32 v22, v54, v37
    v_fmac_f32 v30, v54, v45
    v_fmac_f32 v23, v55, v37
    v_fmac_f32 v31, v55, v45
    v_lshlrev_b32 v48, 16, v120
    v_and_b32 v49, 0xffff0000, v120
    v_lshlrev_b32 v50, 16, v121
    v_and_b32 v51, 0xffff0000, v121
    v_lshlrev_b32 v52, 16, v122
    v_and_b32 v53, 0xffff0000, v122
    v_lshlrev_b32 v54, 16, v123
    v_and_b32 v55, 0xffff0000, v123
    v_fmac_f32 v16, v48, v38
    v_fmac_f32 v24, v48, v46
    v_fmac_f32 v17, v49, v38
    v_fmac_f32 v25, v49, v46
    v_fmac_f32 v18, v50, v38
    v_fmac_f32 v26, v50, v46
    v_fmac_f32 v19, v51, v38
    v_fmac_f32 v27, v51, v46
    v_fmac_f32 v20, v52, v38
    v_fmac_f32 v28, v52, v46
    v_fmac_f32 v21, v53, v38
    v_fmac_f32 v29, v53, v46
    v_fmac_f32 v22, v54, v38
    v_fmac_f32 v30, v54, v46
    v_fmac_f32 v23, v55, v38
    v_fmac_f32 v31, v55, v46
    v_lshlrev_b32 v48, 16, v124
    v_and_b32 v49, 0xffff0000, v124
    v_lshlrev_b32 v50, 16, v125
    v_and_b32 v51, 0xffff0000, v125
    v_lshlrev_b32 v52, 16, v126
    v_and_b32 v53, 0xffff0000, v126
    v_lshlrev_b32 v54, 16, v127
    v_and_b32 v55, 0xffff0000, v127
    v_fmac_f32 v16, v48, v39
    v_fmac_f32 v24, v48, v47
    v_fmac_f32 v17, v49, v39
    v_fmac_f32 v25, v49, v47
    v_fmac_f32 v18, v50, v39
    v_fmac_f32 v26, v50, v47
    v_fmac_f32 v19, v51, v39
    v_fmac_f32 v27, v51, v47
    v_fmac_f32 v20, v52, v39
    v_fmac_f32 v28, v52, v47
    v_fmac_f32 v21, v53, v39
    v_fmac_f32 v29, v53, v47
    v_fmac_f32 v22, v54, v39
    v_fmac_f32 v30, v54, v47
    v_fmac_f32 v23, v55, v39
    v_fmac_f32 v31, v55, v47
    s_barrier
    v_lshlrev_b32 v12, 12, v7
    v_lshlrev_b32 v13, 5, v6
    v_add_u32 v12, v12, v13
    ds_write_b128 v12, v[16:19]
    ds_write_b128 v12, v[20:23] offset:16
    ds_write_b128 v12, v[24:27] offset:2048
    ds_write_b128 v12, v[28:31] offset:2064
    s_waitcnt lgkmcnt(0)
    s_barrier
    v_lshlrev_b32 v12, 4, v0
    ds_read_b128 v[32:35], v12 offset:0
    ds_read_b128 v[36:39], v12 offset:4096
    ds_read_b128 v[40:43], v12 offset:8192
    ds_read_b128 v[44:47], v12 offset:12288
    s_waitcnt lgkmcnt(0)
    v_add_f32 v32, v32, v36
    v_add_f32 v32, v32, v40
    v_add_f32 v32, v32, v44
    v_add_f32 v33, v33, v37
    v_add_f32 v33, v33, v41
    v_add_f32 v33, v33, v45
    v_add_f32 v34, v34, v38
    v_add_f32 v34, v34, v42
    v_add_f32 v34, v34, v46
    v_add_f32 v35, v35, v39
    v_add_f32 v35, v35, v43
    v_add_f32 v35, v35, v47
    s_lshl_b32 s26, s11, 12
    s_add_u32 s26, s26, 0x1000000
    v_add_u32 v12, s26, v12
    global_store_dwordx4 v12, v[32:35], s[4:5]
K3_END:
K3_EXIT:
    s_endpgm
.globl k4fin_kernel
.p2align 8
.type k4fin_kernel,@function
k4fin_kernel:
    s_cmp_ge_u32 s2, 16
    s_cbranch_scc1 K4_EXIT
    s_load_dwordx2 s[4:5], s[0:1], 104
    s_load_dwordx2 s[6:7], s[0:1], 88
    s_lshr_b32 s10, s2, 3
    s_bfe_u32 s11, s2, 0x10002
    s_and_b32 s12, s2, 3
    v_lshrrev_b32 v1, 5, v0
    v_and_b32 v2, 31, v0
    s_lshl_b32 s13, s10, 19
    s_lshl_b32 s14, s11, 11
    s_add_u32 s13, s13, s14
    s_lshl_b32 s14, s12, 9
    s_add_u32 s13, s13, s14
    s_add_u32 s13, s13, 0x1000000
    v_lshlrev_b32 v3, 16, v1
    v_lshlrev_b32 v4, 4, v2
    v_add3_u32 v3, v3, v4, s13
    s_waitcnt lgkmcnt(0)
    global_load_dwordx4 v[16:19], v3, s[4:5]
    v_add_u32 v3, 0x1000, v3
    global_load_dwordx4 v[20:23], v3, s[4:5]
    v_add_u32 v3, 0x1000, v3
    global_load_dwordx4 v[24:27], v3, s[4:5]
    v_add_u32 v3, 0x1000, v3
    global_load_dwordx4 v[28:31], v3, s[4:5]
    v_add_u32 v3, 0x1000, v3
    global_load_dwordx4 v[32:35], v3, s[4:5]
    v_add_u32 v3, 0x1000, v3
    global_load_dwordx4 v[36:39], v3, s[4:5]
    v_add_u32 v3, 0x1000, v3
    global_load_dwordx4 v[40:43], v3, s[4:5]
    v_add_u32 v3, 0x1000, v3
    global_load_dwordx4 v[44:47], v3, s[4:5]
    v_add_u32 v3, 0x1000, v3
    global_load_dwordx4 v[48:51], v3, s[4:5]
    v_add_u32 v3, 0x1000, v3
    global_load_dwordx4 v[52:55], v3, s[4:5]
    v_add_u32 v3, 0x1000, v3
    global_load_dwordx4 v[56:59], v3, s[4:5]
    v_add_u32 v3, 0x1000, v3
    global_load_dwordx4 v[60:63], v3, s[4:5]
    v_add_u32 v3, 0x1000, v3
    global_load_dwordx4 v[64:67], v3, s[4:5]
    v_add_u32 v3, 0x1000, v3
    global_load_dwordx4 v[68:71], v3, s[4:5]
    v_add_u32 v3, 0x1000, v3
    global_load_dwordx4 v[72:75], v3, s[4:5]
    v_add_u32 v3, 0x1000, v3
    global_load_dwordx4 v[76:79], v3, s[4:5]
    s_waitcnt vmcnt(0)
    v_add_f32 v16, v16, v20
    v_add_f32 v17, v17, v21
    v_add_f32 v18, v18, v22
    v_add_f32 v19, v19, v23
    v_add_f32 v16, v16, v24
    v_add_f32 v17, v17, v25
    v_add_f32 v18, v18, v26
    v_add_f32 v19, v19, v27
    v_add_f32 v16, v16, v28
    v_add_f32 v17, v17, v29
    v_add_f32 v18, v18, v30
    v_add_f32 v19, v19, v31
    v_add_f32 v16, v16, v32
    v_add_f32 v17, v17, v33
    v_add_f32 v18, v18, v34
    v_add_f32 v19, v19, v35
    v_add_f32 v16, v16, v36
    v_add_f32 v17, v17, v37
    v_add_f32 v18, v18, v38
    v_add_f32 v19, v19, v39
    v_add_f32 v16, v16, v40
    v_add_f32 v17, v17, v41
    v_add_f32 v18, v18, v42
    v_add_f32 v19, v19, v43
    v_add_f32 v16, v16, v44
    v_add_f32 v17, v17, v45
    v_add_f32 v18, v18, v46
    v_add_f32 v19, v19, v47
    v_add_f32 v16, v16, v48
    v_add_f32 v17, v17, v49
    v_add_f32 v18, v18, v50
    v_add_f32 v19, v19, v51
    v_add_f32 v16, v16, v52
    v_add_f32 v17, v17, v53
    v_add_f32 v18, v18, v54
    v_add_f32 v19, v19, v55
    v_add_f32 v16, v16, v56
    v_add_f32 v17, v17, v57
    v_add_f32 v18, v18, v58
    v_add_f32 v19, v19, v59
    v_add_f32 v16, v16, v60
    v_add_f32 v17, v17, v61
    v_add_f32 v18, v18, v62
    v_add_f32 v19, v19, v63
    v_add_f32 v16, v16, v64
    v_add_f32 v17, v17, v65
    v_add_f32 v18, v18, v66
    v_add_f32 v19, v19, v67
    v_add_f32 v16, v16, v68
    v_add_f32 v17, v17, v69
    v_add_f32 v18, v18, v70
    v_add_f32 v19, v19, v71
    v_add_f32 v16, v16, v72
    v_add_f32 v17, v17, v73
    v_add_f32 v18, v18, v74
    v_add_f32 v19, v19, v75
    v_add_f32 v16, v16, v76
    v_add_f32 v17, v17, v77
    v_add_f32 v18, v18, v78
    v_add_f32 v19, v19, v79
    v_lshlrev_b32 v5, 4, v0
    ds_write_b128 v5, v[16:19]
    s_waitcnt lgkmcnt(0)
    s_barrier
    v_cmp_gt_u32 vcc, 32, v0
    s_nop 1
    s_and_saveexec_b64 s[16:17], vcc
    s_cbranch_execz K4_SKIP
    ds_read_b128 v[16:19], v5 offset:0
    ds_read_b128 v[20:23], v5 offset:512
    ds_read_b128 v[24:27], v5 offset:1024
    ds_read_b128 v[28:31], v5 offset:1536
    ds_read_b128 v[32:35], v5 offset:2048
    ds_read_b128 v[36:39], v5 offset:2560
    ds_read_b128 v[40:43], v5 offset:3072
    ds_read_b128 v[44:47], v5 offset:3584
    s_waitcnt lgkmcnt(0)
    v_add_f32 v16, v16, v20
    v_add_f32 v17, v17, v21
    v_add_f32 v18, v18, v22
    v_add_f32 v19, v19, v23
    v_add_f32 v16, v16, v24
    v_add_f32 v17, v17, v25
    v_add_f32 v18, v18, v26
    v_add_f32 v19, v19, v27
    v_add_f32 v16, v16, v28
    v_add_f32 v17, v17, v29
    v_add_f32 v18, v18, v30
    v_add_f32 v19, v19, v31
    v_add_f32 v16, v16, v32
    v_add_f32 v17, v17, v33
    v_add_f32 v18, v18, v34
    v_add_f32 v19, v19, v35
    v_add_f32 v16, v16, v36
    v_add_f32 v17, v17, v37
    v_add_f32 v18, v18, v38
    v_add_f32 v19, v19, v39
    v_add_f32 v16, v16, v40
    v_add_f32 v17, v17, v41
    v_add_f32 v18, v18, v42
    v_add_f32 v19, v19, v43
    v_add_f32 v16, v16, v44
    v_add_f32 v17, v17, v45
    v_add_f32 v18, v18, v46
    v_add_f32 v19, v19, v47
    v_cvt_pk_bf16_f32 v8, v16, v17
    v_cvt_pk_bf16_f32 v9, v18, v19
    s_lshl_b32 s13, s11, 11
    s_lshl_b32 s14, s10, 10
    s_add_u32 s13, s13, s14
    s_lshl_b32 s14, s12, 8
    s_add_u32 s13, s13, s14
    v_lshlrev_b32 v6, 3, v2
    v_add_u32 v6, s13, v6
    global_store_dwordx2 v6, v[8:9], s[6:7]
K4_SKIP:
    s_mov_b64 exec, s[16:17]
K4_END:
K4_EXIT2:
K4_EXIT:
    s_endpgm
.section .rodata,"a"
.p2align 6
.amdhsa_kernel k1q_kernel
  .amdhsa_next_free_vgpr 256
  .amdhsa_next_free_sgpr 96
  .amdhsa_accum_offset 256
  .amdhsa_group_segment_fixed_size 0
  .amdhsa_kernarg_size 112
  .amdhsa_user_sgpr_count 2
  .amdhsa_user_sgpr_kernarg_segment_ptr 1
  .amdhsa_system_sgpr_workgroup_id_x 1
.end_amdhsa_kernel
.amdhsa_kernel k2att_kernel
  .amdhsa_next_free_vgpr 384
  .amdhsa_next_free_sgpr 96
  .amdhsa_accum_offset 256
  .amdhsa_group_segment_fixed_size 0
  .amdhsa_kernarg_size 112
  .amdhsa_user_sgpr_count 2
  .amdhsa_user_sgpr_kernarg_segment_ptr 1
  .amdhsa_system_sgpr_workgroup_id_x 1
.end_amdhsa_kernel
.amdhsa_kernel k3prj_kernel
  .amdhsa_next_free_vgpr 256
  .amdhsa_next_free_sgpr 96
  .amdhsa_accum_offset 256
  .amdhsa_group_segment_fixed_size 0
  .amdhsa_kernarg_size 112
  .amdhsa_user_sgpr_count 2
  .amdhsa_user_sgpr_kernarg_segment_ptr 1
  .amdhsa_system_sgpr_workgroup_id_x 1
.end_amdhsa_kernel
.amdhsa_kernel k4fin_kernel
  .amdhsa_next_free_vgpr 256
  .amdhsa_next_free_sgpr 96
  .amdhsa_accum_offset 256
  .amdhsa_group_segment_fixed_size 0
  .amdhsa_kernarg_size 112
  .amdhsa_user_sgpr_count 2
  .amdhsa_user_sgpr_kernarg_segment_ptr 1
  .amdhsa_system_sgpr_workgroup_id_x 1
.end_amdhsa_kernel
```
